```python
import torch

def _softmax(x, axis=-1):
    return torch.softmax(x, dim=axis)
def _gelu(x):
    return torch.nn.functional.gelu(x, approximate="tanh")
def _silu(x):
    return torch.nn.functional.silu(x)
def _sigmoid(x):
    return torch.sigmoid(x)
def _layernorm(x, axis=-1, eps=1e-5):
    m = x.mean(dim=axis, keepdim=True)
    v = x.var(dim=axis, keepdim=True, unbiased=False)
    return (x - m) / torch.sqrt(v + eps)
def _scatter_add(tgt, idx, src, axis=0):
    return tgt.clone().index_add_(axis, idx, src)
def _segment_sum(src, seg, n):
    out = torch.zeros((n,) + src.shape[1:], dtype=src.dtype)
    return out.index_add_(0, seg, src)
def _pad(x, pw):
    flat = tuple(v for pair in reversed(pw) for v in pair)
    return torch.nn.functional.pad(x, flat)

kernel_name = 'standalone__deep_cross_pnn__recsys'

def setup_inputs():

    _w = (lambda a: (lambda t: t.to(torch.bfloat16) if t.is_floating_point() else t)(torch.as_tensor(a)))
    B, F, D, V = 4096, 100, 64, min(1000, 100000)
    H = 4 * D
    return {
        "idx": _w((lambda lo, hi, *s: torch.randint(lo, hi, s))(0, V, B, F).to(torch.int64)),
        "table": _w((lambda *s: torch.randn(*s, dtype=torch.bfloat16) * 1.6)(V, D) * (D ** -0.5)),
        "w_p": _w((lambda *s: torch.randn(*s, dtype=torch.bfloat16) * 0.05)(F * F) * ((F * F) ** -0.5)),
        "w1": _w((lambda *s: torch.randn(*s, dtype=torch.bfloat16) * 1.6)(F * D, H) * ((F * D) ** -0.5)),
        "b1": _w((lambda *s: torch.randn(*s, dtype=torch.bfloat16) * 1.6)(H) * 0.01),
        "w2": _w((lambda *s: torch.randn(*s, dtype=torch.bfloat16) * 0.05)(H) * (H ** -0.5)),
        "b2": _w((lambda *s: torch.randn(*s, dtype=torch.bfloat16) * 0.05)(1) * 0.01),
    }

def reference(idx, table, w_p, w1, b1, w2, b2):
    emb = table[idx]
    B = emb.shape[0]; F = emb.shape[1]; D = emb.shape[2]
    ip = torch.einsum('bid,bjd->bij', emb, emb)
    ip = ip.reshape(B, F * F)
    logit_p = ip @ w_p
    z = emb.reshape(B, F * D)
    h = _gelu(z @ w1 + b1)
    logit_d = h @ w2 + b2
    return logit_p + logit_d
```

```asm
; @launch grid=(256,1,1) block=(512,1,1) lds=163840
.amdgcn_target "amdgcn-amd-amdhsa--gfx950"
.text
.globl standalone__deep_cross_pnn__recsys_kernel
.p2align 8
.type standalone__deep_cross_pnn__recsys_kernel,@function
standalone__deep_cross_pnn__recsys_kernel:
    s_cmp_ge_u32 s2, 256
    s_cbranch_scc1 L_end
    s_load_dwordx16 s[4:19], s[0:1], 0
    s_load_dwordx4 s[20:23], s[0:1], 64
    v_and_b32 v1, 63, v0
    v_lshrrev_b32 v2, 6, v0
    s_nop 0
    v_readfirstlane_b32 s24, v2
    s_lshr_b32 s59, s24, 2
    s_and_b32 s24, s24, 3
    s_lshr_b32 s25, s2, 3
    s_and_b32 s26, s2, 7
    s_lshl_b32 s27, s25, 7
    v_and_b32 v2, 7, v1
    v_lshrrev_b32 v3, 4, v1
    s_and_b32 s28, s24, 1
    s_lshl_b32 s28, s28, 2
    v_add_u32 v4, s28, v3
    v_and_b32 v4, 7, v4
    v_xor_b32 v2, v2, v4
    v_lshlrev_b32 v2, 4, v2
    v_lshrrev_b32 v4, 3, v1
    v_lshl_or_b32 v6, v4, 7, v2
    v_lshlrev_b32 v7, 4, v1
    v_and_b32 v2, 15, v1
    v_lshrrev_b32 v4, 2, v2
    v_lshl_add_u32 v4, v3, 2, v4
    s_movk_i32 s29, 200
    v_mul_lo_u32 v4, v4, s29
    v_and_b32 v5, 3, v1
    v_lshl_add_u32 v4, v5, 3, v4
    v_add_u32 v8, 128000, v4
    v_mul_lo_u32 v4, v2, s29
    v_lshl_add_u32 v4, v3, 3, v4
    v_add_u32 v9, 128000, v4
    v_lshrrev_b32 v4, 2, v1
    v_lshlrev_b32 v4, 9, v4
    v_lshl_add_u32 v10, v5, 4, v4
    v_lshrrev_b32 v4, 5, v1
    v_lshlrev_b32 v12, 4, v4
    v_lshlrev_b32 v13, 4, v3
    v_lshrrev_b32 v4, 2, v2
    v_lshrrev_b32 v2, 1, v12
    v_add_u32 v4, v4, v2
    v_lshlrev_b32 v4, 6, v4
    v_and_b32 v2, 1, v3
    v_lshl_add_u32 v4, v2, 5, v4
    v_lshl_add_u32 v4, v5, 3, v4
    s_lshl_b32 s30, s24, 13
    s_add_u32 s30, s30, 128000
    v_add_u32 v11, s30, v4
    v_and_b32 v2, 31, v1
    v_add_u32 v2, s27, v2
    s_movk_i32 s29, 400
    v_mul_lo_u32 v2, v2, s29
    s_mul_i32 s31, s24, 100
    v_add_u32 v2, s31, v2
    v_add_u32 v14, 0, v2
    v_add_u32 v15, 12800, v2
    v_add_u32 v16, 25600, v2
    v_add_u32 v17, 38400, v2
    s_lshl_b32 s31, s26, 4
    s_add_u32 s31, s31, s27
    s_lshl_b32 s32, s24, 2
    s_add_u32 s31, s31, s32
    s_mul_i32 s32, s31, 400
    v_and_b32 v2, 15, v1
    v_lshl_add_u32 v18, v2, 2, s32
    s_waitcnt lgkmcnt(0)
    s_mov_b32 s36, s8
    s_mov_b32 s37, s9
    s_mov_b32 s38, 20000
    s_mov_b32 s39, 0x00020000
    s_cmp_eq_u32 s59, 1
    s_cbranch_scc1 L_fillskip
    s_mul_i32 s33, s25, 200
    s_mul_i32 s34, s24, 50
    s_add_u32 s33, s33, s34
    v_min_u32 v2, 49, v1
    v_add_u32 v2, s33, v2
    v_lshlrev_b32 v2, 9, v2
    s_lshl_b32 s34, s26, 6
    v_add_u32 v2, s34, v2
    global_load_dword v190, v2, s[10:11]
    s_lshl_b32 s33, s24, 10
    s_add_u32 s40, s6, s33
    s_addc_u32 s41, s7, 0
    s_mov_b32 s34, s33
    s_mov_b32 m0, s34
    s_nop 0
    global_load_lds_dwordx4 v6, s[40:41]
    s_add_u32 s40, s40, 4096
    s_addc_u32 s41, s41, 0
    s_add_u32 s34, s34, 4096
    s_mov_b32 m0, s34
    s_nop 0
    global_load_lds_dwordx4 v6, s[40:41]
    s_add_u32 s40, s40, 4096
    s_addc_u32 s41, s41, 0
    s_add_u32 s34, s34, 4096
    s_mov_b32 m0, s34
    s_nop 0
    global_load_lds_dwordx4 v6, s[40:41]
    s_add_u32 s40, s40, 4096
    s_addc_u32 s41, s41, 0
    s_add_u32 s34, s34, 4096
    s_mov_b32 m0, s34
    s_nop 0
    global_load_lds_dwordx4 v6, s[40:41]
    s_add_u32 s40, s40, 4096
    s_addc_u32 s41, s41, 0
    s_add_u32 s34, s34, 4096
    s_mov_b32 m0, s34
    s_nop 0
    global_load_lds_dwordx4 v6, s[40:41]
    s_add_u32 s40, s40, 4096
    s_addc_u32 s41, s41, 0
    s_add_u32 s34, s34, 4096
    s_mov_b32 m0, s34
    s_nop 0
    global_load_lds_dwordx4 v6, s[40:41]
    s_add_u32 s40, s40, 4096
    s_addc_u32 s41, s41, 0
    s_add_u32 s34, s34, 4096
    s_mov_b32 m0, s34
    s_nop 0
    global_load_lds_dwordx4 v6, s[40:41]
    s_add_u32 s40, s40, 4096
    s_addc_u32 s41, s41, 0
    s_add_u32 s34, s34, 4096
    s_mov_b32 m0, s34
    s_nop 0
    global_load_lds_dwordx4 v6, s[40:41]
    s_add_u32 s40, s40, 4096
    s_addc_u32 s41, s41, 0
    s_add_u32 s34, s34, 4096
    s_mov_b32 m0, s34
    s_nop 0
    global_load_lds_dwordx4 v6, s[40:41]
    s_add_u32 s40, s40, 4096
    s_addc_u32 s41, s41, 0
    s_add_u32 s34, s34, 4096
    s_mov_b32 m0, s34
    s_nop 0
    global_load_lds_dwordx4 v6, s[40:41]
    s_add_u32 s40, s40, 4096
    s_addc_u32 s41, s41, 0
    s_add_u32 s34, s34, 4096
    s_mov_b32 m0, s34
    s_nop 0
    global_load_lds_dwordx4 v6, s[40:41]
    s_add_u32 s40, s40, 4096
    s_addc_u32 s41, s41, 0
    s_add_u32 s34, s34, 4096
    s_mov_b32 m0, s34
    s_nop 0
    global_load_lds_dwordx4 v6, s[40:41]
    s_add_u32 s40, s40, 4096
    s_addc_u32 s41, s41, 0
    s_add_u32 s34, s34, 4096
    s_mov_b32 m0, s34
    s_nop 0
    global_load_lds_dwordx4 v6, s[40:41]
    s_add_u32 s40, s40, 4096
    s_addc_u32 s41, s41, 0
    s_add_u32 s34, s34, 4096
    s_mov_b32 m0, s34
    s_nop 0
    global_load_lds_dwordx4 v6, s[40:41]
    s_add_u32 s40, s40, 4096
    s_addc_u32 s41, s41, 0
    s_add_u32 s34, s34, 4096
    s_mov_b32 m0, s34
    s_nop 0
    global_load_lds_dwordx4 v6, s[40:41]
    s_add_u32 s40, s40, 4096
    s_addc_u32 s41, s41, 0
    s_add_u32 s34, s34, 4096
    s_mov_b32 m0, s34
    s_nop 0
    global_load_lds_dwordx4 v6, s[40:41]
    s_add_u32 s40, s40, 4096
    s_addc_u32 s41, s41, 0
    s_add_u32 s34, s34, 4096
    s_mov_b32 m0, s34
    s_nop 0
    global_load_lds_dwordx4 v6, s[40:41]
    s_add_u32 s40, s40, 4096
    s_addc_u32 s41, s41, 0
    s_add_u32 s34, s34, 4096
    s_mov_b32 m0, s34
    s_nop 0
    global_load_lds_dwordx4 v6, s[40:41]
    s_add_u32 s40, s40, 4096
    s_addc_u32 s41, s41, 0
    s_add_u32 s34, s34, 4096
    s_mov_b32 m0, s34
    s_nop 0
    global_load_lds_dwordx4 v6, s[40:41]
    s_add_u32 s40, s40, 4096
    s_addc_u32 s41, s41, 0
    s_add_u32 s34, s34, 4096
    s_mov_b32 m0, s34
    s_nop 0
    global_load_lds_dwordx4 v6, s[40:41]
    s_add_u32 s40, s40, 4096
    s_addc_u32 s41, s41, 0
    s_add_u32 s34, s34, 4096
    s_mov_b32 m0, s34
    s_nop 0
    global_load_lds_dwordx4 v6, s[40:41]
    s_add_u32 s40, s40, 4096
    s_addc_u32 s41, s41, 0
    s_add_u32 s34, s34, 4096
    s_mov_b32 m0, s34
    s_nop 0
    global_load_lds_dwordx4 v6, s[40:41]
    s_add_u32 s40, s40, 4096
    s_addc_u32 s41, s41, 0
    s_add_u32 s34, s34, 4096
    s_mov_b32 m0, s34
    s_nop 0
    global_load_lds_dwordx4 v6, s[40:41]
    s_add_u32 s40, s40, 4096
    s_addc_u32 s41, s41, 0
    s_add_u32 s34, s34, 4096
    s_mov_b32 m0, s34
    s_nop 0
    global_load_lds_dwordx4 v6, s[40:41]
    s_add_u32 s40, s40, 4096
    s_addc_u32 s41, s41, 0
    s_add_u32 s34, s34, 4096
    s_mov_b32 m0, s34
    s_nop 0
    global_load_lds_dwordx4 v6, s[40:41]
    s_add_u32 s40, s40, 4096
    s_addc_u32 s41, s41, 0
    s_add_u32 s34, s34, 4096
    s_mov_b32 m0, s34
    s_nop 0
    global_load_lds_dwordx4 v6, s[40:41]
    s_add_u32 s40, s40, 4096
    s_addc_u32 s41, s41, 0
    s_add_u32 s34, s34, 4096
    s_mov_b32 m0, s34
    s_nop 0
    global_load_lds_dwordx4 v6, s[40:41]
    s_add_u32 s40, s40, 4096
    s_addc_u32 s41, s41, 0
    s_add_u32 s34, s34, 4096
    s_mov_b32 m0, s34
    s_nop 0
    global_load_lds_dwordx4 v6, s[40:41]
    s_add_u32 s40, s40, 4096
    s_addc_u32 s41, s41, 0
    s_add_u32 s34, s34, 4096
    s_mov_b32 m0, s34
    s_nop 0
    global_load_lds_dwordx4 v6, s[40:41]
    s_add_u32 s40, s40, 4096
    s_addc_u32 s41, s41, 0
    s_add_u32 s34, s34, 4096
    s_mov_b32 m0, s34
    s_nop 0
    global_load_lds_dwordx4 v6, s[40:41]
    s_add_u32 s40, s40, 4096
    s_addc_u32 s41, s41, 0
    s_add_u32 s34, s34, 4096
    s_mov_b32 m0, s34
    s_nop 0
    global_load_lds_dwordx4 v6, s[40:41]
    s_add_u32 s40, s40, 4096
    s_addc_u32 s41, s41, 0
    s_add_u32 s34, s34, 4096
    s_cmp_lg_u32 s24, 0
    s_cbranch_scc1 L_tabdone
    s_mov_b32 m0, s34
    s_nop 0
    global_load_lds_dwordx4 v6, s[40:41]
    s_add_u32 s40, s40, 4096
    s_addc_u32 s41, s41, 0
    s_add_u32 s34, s34, 4096
L_tabdone:
    s_add_u32 s34, s33, 128000
    s_mov_b32 m0, s34
    s_nop 0
    buffer_load_dwordx4 v7, s[36:39], s33 offen lds
    s_add_u32 s33, s33, 4096
    s_add_u32 s34, s34, 4096
    s_mov_b32 m0, s34
    s_nop 0
    buffer_load_dwordx4 v7, s[36:39], s33 offen lds
    s_add_u32 s33, s33, 4096
    s_add_u32 s34, s34, 4096
    s_mov_b32 m0, s34
    s_nop 0
    buffer_load_dwordx4 v7, s[36:39], s33 offen lds
    s_add_u32 s33, s33, 4096
    s_add_u32 s34, s34, 4096
    s_mov_b32 m0, s34
    s_nop 0
    buffer_load_dwordx4 v7, s[36:39], s33 offen lds
    s_add_u32 s33, s33, 4096
    s_add_u32 s34, s34, 4096
    s_mov_b32 m0, s34
    s_nop 0
    buffer_load_dwordx4 v7, s[36:39], s33 offen lds
    s_add_u32 s33, s33, 4096
    s_add_u32 s34, s34, 4096
L_fillskip:
    s_waitcnt vmcnt(0)
    s_barrier
    s_cmp_eq_u32 s59, 0
    s_cbranch_scc1 L_mlprole
    v_and_b32 v2, 15, v1
    v_cmp_gt_u32 s[42:43], 4, v2
    v_cmp_gt_u32 s[44:45], 16, v1
    s_and_b64 s[44:45], s[44:45], s[42:43]
    s_mov_b32 s46, 0xffff0000
    ds_read_b64_tr_b16 v[44:45], v8 offset:0
    ds_read_b64_tr_b16 v[48:49], v8 offset:32
    ds_read_b64 v[50:51], v9 offset:3200
    ds_read_b64_tr_b16 v[52:53], v8 offset:64
    ds_read_b64 v[54:55], v9 offset:6400
    ds_read_b64_tr_b16 v[56:57], v8 offset:96
    ds_read_b64 v[58:59], v9 offset:9600
    ds_read_b64_tr_b16 v[60:61], v8 offset:128
    ds_read_b64 v[62:63], v9 offset:12800
    ds_read_b64_tr_b16 v[64:65], v8 offset:160
    ds_read_b64 v[66:67], v9 offset:16000
    ds_read_b64_tr_b16 v[68:69], v8 offset:192
    ds_read_b64 v[70:71], v9 offset:19200
    s_waitcnt lgkmcnt(0)
    v_lshlrev_b32 v72, 16, v44
    v_and_b32 v73, s46, v44
    v_lshlrev_b32 v74, 16, v45
    v_and_b32 v75, s46, v45
    v_lshlrev_b32 v76, 16, v48
    v_and_b32 v77, s46, v48
    v_lshlrev_b32 v2, 16, v50
    v_and_b32 v3, s46, v50
    v_add_f32 v76, v76, v2
    v_add_f32 v77, v77, v3
    v_lshlrev_b32 v78, 16, v49
    v_and_b32 v79, s46, v49
    v_lshlrev_b32 v2, 16, v51
    v_and_b32 v3, s46, v51
    v_add_f32 v78, v78, v2
    v_add_f32 v79, v79, v3
    v_lshlrev_b32 v80, 16, v52
    v_and_b32 v81, s46, v52
    v_lshlrev_b32 v2, 16, v54
    v_and_b32 v3, s46, v54
    v_add_f32 v80, v80, v2
    v_add_f32 v81, v81, v3
    v_lshlrev_b32 v82, 16, v53
    v_and_b32 v83, s46, v53
    v_lshlrev_b32 v2, 16, v55
    v_and_b32 v3, s46, v55
    v_add_f32 v82, v82, v2
    v_add_f32 v83, v83, v3
    v_lshlrev_b32 v84, 16, v56
    v_and_b32 v85, s46, v56
    v_lshlrev_b32 v2, 16, v58
    v_and_b32 v3, s46, v58
    v_add_f32 v84, v84, v2
    v_add_f32 v85, v85, v3
    v_lshlrev_b32 v86, 16, v57
    v_and_b32 v87, s46, v57
    v_lshlrev_b32 v2, 16, v59
    v_and_b32 v3, s46, v59
    v_add_f32 v86, v86, v2
    v_add_f32 v87, v87, v3
    v_lshlrev_b32 v88, 16, v60
    v_and_b32 v89, s46, v60
    v_lshlrev_b32 v2, 16, v62
    v_and_b32 v3, s46, v62
    v_add_f32 v88, v88, v2
    v_add_f32 v89, v89, v3
    v_lshlrev_b32 v90, 16, v61
    v_and_b32 v91, s46, v61
    v_lshlrev_b32 v2, 16, v63
    v_and_b32 v3, s46, v63
    v_add_f32 v90, v90, v2
    v_add_f32 v91, v91, v3
    v_lshlrev_b32 v92, 16, v64
    v_and_b32 v93, s46, v64
    v_lshlrev_b32 v2, 16, v66
    v_and_b32 v3, s46, v66
    v_add_f32 v92, v92, v2
    v_add_f32 v93, v93, v3
    v_lshlrev_b32 v94, 16, v65
    v_and_b32 v95, s46, v65
    v_lshlrev_b32 v2, 16, v67
    v_and_b32 v3, s46, v67
    v_add_f32 v94, v94, v2
    v_add_f32 v95, v95, v3
    v_lshlrev_b32 v96, 16, v68
    v_and_b32 v97, s46, v68
    v_lshlrev_b32 v2, 16, v70
    v_and_b32 v3, s46, v70
    v_add_f32 v96, v96, v2
    v_add_f32 v97, v97, v3
    v_lshlrev_b32 v98, 16, v69
    v_and_b32 v99, s46, v69
    v_lshlrev_b32 v2, 16, v71
    v_and_b32 v3, s46, v71
    v_add_f32 v98, v98, v2
    v_add_f32 v99, v99, v3
    v_cndmask_b32 v96, 0, v96, s[42:43]
    v_cndmask_b32 v97, 0, v97, s[42:43]
    v_cndmask_b32 v98, 0, v98, s[42:43]
    v_cndmask_b32 v99, 0, v99, s[42:43]
    ds_read_b64_tr_b16 v[44:45], v8 offset:3232
    ds_read_b64_tr_b16 v[48:49], v8 offset:3264
    ds_read_b64 v[50:51], v9 offset:6432
    ds_read_b64_tr_b16 v[52:53], v8 offset:3296
    ds_read_b64 v[54:55], v9 offset:9632
    ds_read_b64_tr_b16 v[56:57], v8 offset:3328
    ds_read_b64 v[58:59], v9 offset:12832
    ds_read_b64_tr_b16 v[60:61], v8 offset:3360
    ds_read_b64 v[62:63], v9 offset:16032
    ds_read_b64_tr_b16 v[64:65], v8 offset:3392
    ds_read_b64 v[66:67], v9 offset:19232
    ds_read_b64_tr_b16 v[68:69], v8 offset:6464
    s_waitcnt lgkmcnt(0)
    v_lshlrev_b32 v100, 16, v44
    v_and_b32 v101, s46, v44
    v_lshlrev_b32 v102, 16, v45
    v_and_b32 v103, s46, v45
    v_lshlrev_b32 v104, 16, v48
    v_and_b32 v105, s46, v48
    v_lshlrev_b32 v2, 16, v50
    v_and_b32 v3, s46, v50
    v_add_f32 v104, v104, v2
    v_add_f32 v105, v105, v3
    v_lshlrev_b32 v106, 16, v49
    v_and_b32 v107, s46, v49
    v_lshlrev_b32 v2, 16, v51
    v_and_b32 v3, s46, v51
    v_add_f32 v106, v106, v2
    v_add_f32 v107, v107, v3
    v_lshlrev_b32 v108, 16, v52
    v_and_b32 v109, s46, v52
    v_lshlrev_b32 v2, 16, v54
    v_and_b32 v3, s46, v54
    v_add_f32 v108, v108, v2
    v_add_f32 v109, v109, v3
    v_lshlrev_b32 v110, 16, v53
    v_and_b32 v111, s46, v53
    v_lshlrev_b32 v2, 16, v55
    v_and_b32 v3, s46, v55
    v_add_f32 v110, v110, v2
    v_add_f32 v111, v111, v3
    v_lshlrev_b32 v112, 16, v56
    v_and_b32 v113, s46, v56
    v_lshlrev_b32 v2, 16, v58
    v_and_b32 v3, s46, v58
    v_add_f32 v112, v112, v2
    v_add_f32 v113, v113, v3
    v_lshlrev_b32 v114, 16, v57
    v_and_b32 v115, s46, v57
    v_lshlrev_b32 v2, 16, v59
    v_and_b32 v3, s46, v59
    v_add_f32 v114, v114, v2
    v_add_f32 v115, v115, v3
    v_lshlrev_b32 v116, 16, v60
    v_and_b32 v117, s46, v60
    v_lshlrev_b32 v2, 16, v62
    v_and_b32 v3, s46, v62
    v_add_f32 v116, v116, v2
    v_add_f32 v117, v117, v3
    v_lshlrev_b32 v118, 16, v61
    v_and_b32 v119, s46, v61
    v_lshlrev_b32 v2, 16, v63
    v_and_b32 v3, s46, v63
    v_add_f32 v118, v118, v2
    v_add_f32 v119, v119, v3
    v_lshlrev_b32 v120, 16, v64
    v_and_b32 v121, s46, v64
    v_lshlrev_b32 v2, 16, v66
    v_and_b32 v3, s46, v66
    v_add_f32 v120, v120, v2
    v_add_f32 v121, v121, v3
    v_lshlrev_b32 v122, 16, v65
    v_and_b32 v123, s46, v65
    v_lshlrev_b32 v2, 16, v67
    v_and_b32 v3, s46, v67
    v_add_f32 v122, v122, v2
    v_add_f32 v123, v123, v3
    v_cndmask_b32 v120, 0, v120, s[42:43]
    v_cndmask_b32 v121, 0, v121, s[42:43]
    v_cndmask_b32 v122, 0, v122, s[42:43]
    v_cndmask_b32 v123, 0, v123, s[42:43]
    v_lshlrev_b32 v124, 16, v68
    v_and_b32 v125, s46, v68
    v_lshlrev_b32 v126, 16, v69
    v_and_b32 v127, s46, v69
    ds_read_b64_tr_b16 v[44:45], v8 offset:6496
    ds_read_b64 v[46:47], v9 offset:9664
    ds_read_b64_tr_b16 v[48:49], v8 offset:6528
    ds_read_b64 v[50:51], v9 offset:12864
    ds_read_b64_tr_b16 v[52:53], v8 offset:6560
    ds_read_b64 v[54:55], v9 offset:16064
    ds_read_b64_tr_b16 v[56:57], v8 offset:6592
    ds_read_b64 v[58:59], v9 offset:19264
    ds_read_b64_tr_b16 v[60:61], v8 offset:9696
    ds_read_b64_tr_b16 v[64:65], v8 offset:9728
    ds_read_b64 v[66:67], v9 offset:12896
    ds_read_b64_tr_b16 v[68:69], v8 offset:9760
    ds_read_b64 v[70:71], v9 offset:16096
    s_waitcnt lgkmcnt(0)
    v_lshlrev_b32 v128, 16, v44
    v_and_b32 v129, s46, v44
    v_lshlrev_b32 v2, 16, v46
    v_and_b32 v3, s46, v46
    v_add_f32 v128, v128, v2
    v_add_f32 v129, v129, v3
    v_lshlrev_b32 v130, 16, v45
    v_and_b32 v131, s46, v45
    v_lshlrev_b32 v2, 16, v47
    v_and_b32 v3, s46, v47
    v_add_f32 v130, v130, v2
    v_add_f32 v131, v131, v3
    v_lshlrev_b32 v132, 16, v48
    v_and_b32 v133, s46, v48
    v_lshlrev_b32 v2, 16, v50
    v_and_b32 v3, s46, v50
    v_add_f32 v132, v132, v2
    v_add_f32 v133, v133, v3
    v_lshlrev_b32 v134, 16, v49
    v_and_b32 v135, s46, v49
    v_lshlrev_b32 v2, 16, v51
    v_and_b32 v3, s46, v51
    v_add_f32 v134, v134, v2
    v_add_f32 v135, v135, v3
    v_lshlrev_b32 v136, 16, v52
    v_and_b32 v137, s46, v52
    v_lshlrev_b32 v2, 16, v54
    v_and_b32 v3, s46, v54
    v_add_f32 v136, v136, v2
    v_add_f32 v137, v137, v3
    v_lshlrev_b32 v138, 16, v53
    v_and_b32 v139, s46, v53
    v_lshlrev_b32 v2, 16, v55
    v_and_b32 v3, s46, v55
    v_add_f32 v138, v138, v2
    v_add_f32 v139, v139, v3
    v_lshlrev_b32 v140, 16, v56
    v_and_b32 v141, s46, v56
    v_lshlrev_b32 v2, 16, v58
    v_and_b32 v3, s46, v58
    v_add_f32 v140, v140, v2
    v_add_f32 v141, v141, v3
    v_lshlrev_b32 v142, 16, v57
    v_and_b32 v143, s46, v57
    v_lshlrev_b32 v2, 16, v59
    v_and_b32 v3, s46, v59
    v_add_f32 v142, v142, v2
    v_add_f32 v143, v143, v3
    v_cndmask_b32 v140, 0, v140, s[42:43]
    v_cndmask_b32 v141, 0, v141, s[42:43]
    v_cndmask_b32 v142, 0, v142, s[42:43]
    v_cndmask_b32 v143, 0, v143, s[42:43]
    v_lshlrev_b32 v144, 16, v60
    v_and_b32 v145, s46, v60
    v_lshlrev_b32 v146, 16, v61
    v_and_b32 v147, s46, v61
    v_lshlrev_b32 v148, 16, v64
    v_and_b32 v149, s46, v64
    v_lshlrev_b32 v2, 16, v66
    v_and_b32 v3, s46, v66
    v_add_f32 v148, v148, v2
    v_add_f32 v149, v149, v3
    v_lshlrev_b32 v150, 16, v65
    v_and_b32 v151, s46, v65
    v_lshlrev_b32 v2, 16, v67
    v_and_b32 v3, s46, v67
    v_add_f32 v150, v150, v2
    v_add_f32 v151, v151, v3
    v_lshlrev_b32 v152, 16, v68
    v_and_b32 v153, s46, v68
    v_lshlrev_b32 v2, 16, v70
    v_and_b32 v3, s46, v70
    v_add_f32 v152, v152, v2
    v_add_f32 v153, v153, v3
    v_lshlrev_b32 v154, 16, v69
    v_and_b32 v155, s46, v69
    v_lshlrev_b32 v2, 16, v71
    v_and_b32 v3, s46, v71
    v_add_f32 v154, v154, v2
    v_add_f32 v155, v155, v3
    ds_read_b64_tr_b16 v[44:45], v8 offset:9792
    ds_read_b64 v[46:47], v9 offset:19296
    ds_read_b64_tr_b16 v[48:49], v8 offset:12928
    ds_read_b64_tr_b16 v[52:53], v8 offset:12960
    ds_read_b64 v[54:55], v9 offset:16128
    ds_read_b64_tr_b16 v[56:57], v8 offset:12992
    ds_read_b64 v[58:59], v9 offset:19328
    ds_read_b64_tr_b16 v[60:61], v8 offset:16160
    ds_read_b64_tr_b16 v[64:65], v8 offset:16192
    ds_read_b64 v[66:67], v9 offset:19360
    ds_read_b64_tr_b16 v[68:69], v8 offset:19392
    s_waitcnt lgkmcnt(0)
    v_lshlrev_b32 v156, 16, v44
    v_and_b32 v157, s46, v44
    v_lshlrev_b32 v2, 16, v46
    v_and_b32 v3, s46, v46
    v_add_f32 v156, v156, v2
    v_add_f32 v157, v157, v3
    v_lshlrev_b32 v158, 16, v45
    v_and_b32 v159, s46, v45
    v_lshlrev_b32 v2, 16, v47
    v_and_b32 v3, s46, v47
    v_add_f32 v158, v158, v2
    v_add_f32 v159, v159, v3
    v_cndmask_b32 v156, 0, v156, s[42:43]
    v_cndmask_b32 v157, 0, v157, s[42:43]
    v_cndmask_b32 v158, 0, v158, s[42:43]
    v_cndmask_b32 v159, 0, v159, s[42:43]
    v_lshlrev_b32 v160, 16, v48
    v_and_b32 v161, s46, v48
    v_lshlrev_b32 v162, 16, v49
    v_and_b32 v163, s46, v49
    v_lshlrev_b32 v164, 16, v52
    v_and_b32 v165, s46, v52
    v_lshlrev_b32 v2, 16, v54
    v_and_b32 v3, s46, v54
    v_add_f32 v164, v164, v2
    v_add_f32 v165, v165, v3
    v_lshlrev_b32 v166, 16, v53
    v_and_b32 v167, s46, v53
    v_lshlrev_b32 v2, 16, v55
    v_and_b32 v3, s46, v55
    v_add_f32 v166, v166, v2
    v_add_f32 v167, v167, v3
    v_lshlrev_b32 v168, 16, v56
    v_and_b32 v169, s46, v56
    v_lshlrev_b32 v2, 16, v58
    v_and_b32 v3, s46, v58
    v_add_f32 v168, v168, v2
    v_add_f32 v169, v169, v3
    v_lshlrev_b32 v170, 16, v57
    v_and_b32 v171, s46, v57
    v_lshlrev_b32 v2, 16, v59
    v_and_b32 v3, s46, v59
    v_add_f32 v170, v170, v2
    v_add_f32 v171, v171, v3
    v_cndmask_b32 v168, 0, v168, s[42:43]
    v_cndmask_b32 v169, 0, v169, s[42:43]
    v_cndmask_b32 v170, 0, v170, s[42:43]
    v_cndmask_b32 v171, 0, v171, s[42:43]
    v_lshlrev_b32 v172, 16, v60
    v_and_b32 v173, s46, v60
    v_lshlrev_b32 v174, 16, v61
    v_and_b32 v175, s46, v61
    v_lshlrev_b32 v176, 16, v64
    v_and_b32 v177, s46, v64
    v_lshlrev_b32 v2, 16, v66
    v_and_b32 v3, s46, v66
    v_add_f32 v176, v176, v2
    v_add_f32 v177, v177, v3
    v_lshlrev_b32 v178, 16, v65
    v_and_b32 v179, s46, v65
    v_lshlrev_b32 v2, 16, v67
    v_and_b32 v3, s46, v67
    v_add_f32 v178, v178, v2
    v_add_f32 v179, v179, v3
    v_cndmask_b32 v176, 0, v176, s[42:43]
    v_cndmask_b32 v177, 0, v177, s[42:43]
    v_cndmask_b32 v178, 0, v178, s[42:43]
    v_cndmask_b32 v179, 0, v179, s[42:43]
    v_lshlrev_b32 v180, 16, v68
    v_and_b32 v181, s46, v68
    v_lshlrev_b32 v182, 16, v69
    v_and_b32 v183, s46, v69
    v_cndmask_b32 v180, 0, v180, s[44:45]
    v_cndmask_b32 v181, 0, v181, s[44:45]
    v_cndmask_b32 v182, 0, v182, s[44:45]
    v_cndmask_b32 v183, 0, v183, s[44:45]
    s_barrier
    v_and_b32 v2, 15, v1
    v_min_u32 v2, 3, v2
    v_lshl_add_u32 v5, v2, 2, s32
    global_load_dword v44, v18, s[4:5] offset:0
    global_load_dword v45, v18, s[4:5] offset:64
    global_load_dword v46, v18, s[4:5] offset:128
    global_load_dword v47, v18, s[4:5] offset:192
    global_load_dword v48, v18, s[4:5] offset:256
    global_load_dword v49, v18, s[4:5] offset:320
    global_load_dword v50, v5, s[4:5] offset:384
    global_load_dword v51, v18, s[4:5] offset:400
    global_load_dword v52, v18, s[4:5] offset:464
    global_load_dword v53, v18, s[4:5] offset:528
    global_load_dword v54, v18, s[4:5] offset:592
    global_load_dword v55, v18, s[4:5] offset:656
    global_load_dword v56, v18, s[4:5] offset:720
    global_load_dword v57, v5, s[4:5] offset:784
    global_load_dword v58, v18, s[4:5] offset:800
    global_load_dword v59, v18, s[4:5] offset:864
    global_load_dword v60, v18, s[4:5] offset:928
    global_load_dword v61, v18, s[4:5] offset:992
    global_load_dword v62, v18, s[4:5] offset:1056
    global_load_dword v63, v18, s[4:5] offset:1120
    global_load_dword v64, v5, s[4:5] offset:1184
    global_load_dword v65, v18, s[4:5] offset:1200
    global_load_dword v66, v18, s[4:5] offset:1264
    global_load_dword v67, v18, s[4:5] offset:1328
    global_load_dword v68, v18, s[4:5] offset:1392
    global_load_dword v69, v18, s[4:5] offset:1456
    global_load_dword v70, v18, s[4:5] offset:1520
    global_load_dword v71, v5, s[4:5] offset:1584
    s_waitcnt vmcnt(0)
    s_mov_b32 s48, 0
    s_lshl_b32 s50, s31, 2
    s_add_u32 s50, s50, 131072
L_pnn:
    v_bfe_u32 v2, v44, 1, 3
    v_lshlrev_b32 v3, 7, v44
    v_lshl_or_b32 v2, v2, 4, v3
    v_xor_b32 v42, v2, v13
    v_xor_b32 v43, 64, v42
    ds_read_b128 a[0:3], v42
    ds_read_b128 a[4:7], v43
    v_bfe_u32 v2, v45, 1, 3
    v_lshlrev_b32 v3, 7, v45
    v_lshl_or_b32 v2, v2, 4, v3
    v_xor_b32 v42, v2, v13
    v_xor_b32 v43, 64, v42
    ds_read_b128 a[8:11], v42
    ds_read_b128 a[12:15], v43
    v_bfe_u32 v2, v46, 1, 3
    v_lshlrev_b32 v3, 7, v46
    v_lshl_or_b32 v2, v2, 4, v3
    v_xor_b32 v42, v2, v13
    v_xor_b32 v43, 64, v42
    ds_read_b128 a[16:19], v42
    ds_read_b128 a[20:23], v43
    v_bfe_u32 v2, v47, 1, 3
    v_lshlrev_b32 v3, 7, v47
    v_lshl_or_b32 v2, v2, 4, v3
    v_xor_b32 v42, v2, v13
    v_xor_b32 v43, 64, v42
    ds_read_b128 a[24:27], v42
    ds_read_b128 a[28:31], v43
    v_bfe_u32 v2, v48, 1, 3
    v_lshlrev_b32 v3, 7, v48
    v_lshl_or_b32 v2, v2, 4, v3
    v_xor_b32 v42, v2, v13
    v_xor_b32 v43, 64, v42
    ds_read_b128 a[32:35], v42
    ds_read_b128 a[36:39], v43
    v_bfe_u32 v2, v49, 1, 3
    v_lshlrev_b32 v3, 7, v49
    v_lshl_or_b32 v2, v2, 4, v3
    v_xor_b32 v42, v2, v13
    v_xor_b32 v43, 64, v42
    ds_read_b128 a[40:43], v42
    ds_read_b128 a[44:47], v43
    v_bfe_u32 v2, v50, 1, 3
    v_lshlrev_b32 v3, 7, v50
    v_lshl_or_b32 v2, v2, 4, v3
    v_xor_b32 v42, v2, v13
    v_xor_b32 v43, 64, v42
    ds_read_b128 a[48:51], v42
    ds_read_b128 a[52:55], v43
    v_mov_b32 v44, v51
    v_mov_b32 v45, v52
    v_mov_b32 v46, v53
    v_mov_b32 v47, v54
    v_mov_b32 v48, v55
    v_mov_b32 v49, v56
    v_mov_b32 v50, v57
    v_mov_b32 v51, v58
    v_mov_b32 v52, v59
    v_mov_b32 v53, v60
    v_mov_b32 v54, v61
    v_mov_b32 v55, v62
    v_mov_b32 v56, v63
    v_mov_b32 v57, v64
    v_mov_b32 v58, v65
    v_mov_b32 v59, v66
    v_mov_b32 v60, v67
    v_mov_b32 v61, v68
    v_mov_b32 v62, v69
    v_mov_b32 v63, v70
    v_mov_b32 v64, v71
    v_mov_b32 v20, 0
    v_mov_b32 v21, 0
    v_mov_b32 v22, 0
    v_mov_b32 v23, 0
    s_waitcnt lgkmcnt(0)
    v_mfma_f32_16x16x32_bf16 v[24:27], a[0:3], a[0:3], 0
    v_mfma_f32_16x16x32_bf16 v[24:27], a[4:7], a[4:7], v[24:27]
    v_mfma_f32_16x16x32_bf16 v[28:31], a[0:3], a[8:11], 0
    v_mfma_f32_16x16x32_bf16 v[28:31], a[4:7], a[12:15], v[28:31]
    v_mfma_f32_16x16x32_bf16 v[32:35], a[0:3], a[16:19], 0
    v_mfma_f32_16x16x32_bf16 v[32:35], a[4:7], a[20:23], v[32:35]
    s_nop 4
    v_cvt_pk_bf16_f32 v40, v24, v25
    v_cvt_pk_bf16_f32 v41, v26, v27
    v_lshlrev_b32 v24, 16, v40
    v_and_b32 v25, s46, v40
    v_lshlrev_b32 v26, 16, v41
    v_and_b32 v27, s46, v41
    v_fmac_f32 v20, v24, v72
    v_fmac_f32 v21, v25, v73
    v_fmac_f32 v22, v26, v74
    v_fmac_f32 v23, v27, v75
    v_mfma_f32_16x16x32_bf16 v[36:39], a[0:3], a[24:27], 0
    v_mfma_f32_16x16x32_bf16 v[36:39], a[4:7], a[28:31], v[36:39]
    v_cvt_pk_bf16_f32 v40, v28, v29
    v_cvt_pk_bf16_f32 v41, v30, v31
    v_lshlrev_b32 v28, 16, v40
    v_and_b32 v29, s46, v40
    v_lshlrev_b32 v30, 16, v41
    v_and_b32 v31, s46, v41
    v_fmac_f32 v20, v28, v76
    v_fmac_f32 v21, v29, v77
    v_fmac_f32 v22, v30, v78
    v_fmac_f32 v23, v31, v79
    v_mfma_f32_16x16x32_bf16 v[24:27], a[0:3], a[32:35], 0
    v_mfma_f32_16x16x32_bf16 v[24:27], a[4:7], a[36:39], v[24:27]
    v_cvt_pk_bf16_f32 v40, v32, v33
    v_cvt_pk_bf16_f32 v41, v34, v35
    v_lshlrev_b32 v32, 16, v40
    v_and_b32 v33, s46, v40
    v_lshlrev_b32 v34, 16, v41
    v_and_b32 v35, s46, v41
    v_fmac_f32 v20, v32, v80
    v_fmac_f32 v21, v33, v81
    v_fmac_f32 v22, v34, v82
    v_fmac_f32 v23, v35, v83
    v_mfma_f32_16x16x32_bf16 v[28:31], a[0:3], a[40:43], 0
    v_mfma_f32_16x16x32_bf16 v[28:31], a[4:7], a[44:47], v[28:31]
    v_cvt_pk_bf16_f32 v40, v36, v37
    v_cvt_pk_bf16_f32 v41, v38, v39
    v_lshlrev_b32 v36, 16, v40
    v_and_b32 v37, s46, v40
    v_lshlrev_b32 v38, 16, v41
    v_and_b32 v39, s46, v41
    v_fmac_f32 v20, v36, v84
    v_fmac_f32 v21, v37, v85
    v_fmac_f32 v22, v38, v86
    v_fmac_f32 v23, v39, v87
    v_mfma_f32_16x16x32_bf16 v[32:35], a[0:3], a[48:51], 0
    v_mfma_f32_16x16x32_bf16 v[32:35], a[4:7], a[52:55], v[32:35]
    v_cvt_pk_bf16_f32 v40, v24, v25
    v_cvt_pk_bf16_f32 v41, v26, v27
    v_lshlrev_b32 v24, 16, v40
    v_and_b32 v25, s46, v40
    v_lshlrev_b32 v26, 16, v41
    v_and_b32 v27, s46, v41
    v_fmac_f32 v20, v24, v88
    v_fmac_f32 v21, v25, v89
    v_fmac_f32 v22, v26, v90
    v_fmac_f32 v23, v27, v91
    v_mfma_f32_16x16x32_bf16 v[36:39], a[8:11], a[8:11], 0
    v_mfma_f32_16x16x32_bf16 v[36:39], a[12:15], a[12:15], v[36:39]
    v_cvt_pk_bf16_f32 v40, v28, v29
    v_cvt_pk_bf16_f32 v41, v30, v31
    v_lshlrev_b32 v28, 16, v40
    v_and_b32 v29, s46, v40
    v_lshlrev_b32 v30, 16, v41
    v_and_b32 v31, s46, v41
    v_fmac_f32 v20, v28, v92
    v_fmac_f32 v21, v29, v93
    v_fmac_f32 v22, v30, v94
    v_fmac_f32 v23, v31, v95
    v_mfma_f32_16x16x32_bf16 v[24:27], a[8:11], a[16:19], 0
    v_mfma_f32_16x16x32_bf16 v[24:27], a[12:15], a[20:23], v[24:27]
    v_cvt_pk_bf16_f32 v40, v32, v33
    v_cvt_pk_bf16_f32 v41, v34, v35
    v_lshlrev_b32 v32, 16, v40
    v_and_b32 v33, s46, v40
    v_lshlrev_b32 v34, 16, v41
    v_and_b32 v35, s46, v41
    v_fmac_f32 v20, v32, v96
    v_fmac_f32 v21, v33, v97
    v_fmac_f32 v22, v34, v98
    v_fmac_f32 v23, v35, v99
    v_mfma_f32_16x16x32_bf16 v[28:31], a[8:11], a[24:27], 0
    v_mfma_f32_16x16x32_bf16 v[28:31], a[12:15], a[28:31], v[28:31]
    v_cvt_pk_bf16_f32 v40, v36, v37
    v_cvt_pk_bf16_f32 v41, v38, v39
    v_lshlrev_b32 v36, 16, v40
    v_and_b32 v37, s46, v40
    v_lshlrev_b32 v38, 16, v41
    v_and_b32 v39, s46, v41
    v_fmac_f32 v20, v36, v100
    v_fmac_f32 v21, v37, v101
    v_fmac_f32 v22, v38, v102
    v_fmac_f32 v23, v39, v103
    v_mfma_f32_16x16x32_bf16 v[32:35], a[8:11], a[32:35], 0
    v_mfma_f32_16x16x32_bf16 v[32:35], a[12:15], a[36:39], v[32:35]
    v_cvt_pk_bf16_f32 v40, v24, v25
    v_cvt_pk_bf16_f32 v41, v26, v27
    v_lshlrev_b32 v24, 16, v40
    v_and_b32 v25, s46, v40
    v_lshlrev_b32 v26, 16, v41
    v_and_b32 v27, s46, v41
    v_fmac_f32 v20, v24, v104
    v_fmac_f32 v21, v25, v105
    v_fmac_f32 v22, v26, v106
    v_fmac_f32 v23, v27, v107
    v_mfma_f32_16x16x32_bf16 v[36:39], a[8:11], a[40:43], 0
    v_mfma_f32_16x16x32_bf16 v[36:39], a[12:15], a[44:47], v[36:39]
    v_cvt_pk_bf16_f32 v40, v28, v29
    v_cvt_pk_bf16_f32 v41, v30, v31
    v_lshlrev_b32 v28, 16, v40
    v_and_b32 v29, s46, v40
    v_lshlrev_b32 v30, 16, v41
    v_and_b32 v31, s46, v41
    v_fmac_f32 v20, v28, v108
    v_fmac_f32 v21, v29, v109
    v_fmac_f32 v22, v30, v110
    v_fmac_f32 v23, v31, v111
    v_mfma_f32_16x16x32_bf16 v[24:27], a[8:11], a[48:51], 0
    v_mfma_f32_16x16x32_bf16 v[24:27], a[12:15], a[52:55], v[24:27]
    v_cvt_pk_bf16_f32 v40, v32, v33
    v_cvt_pk_bf16_f32 v41, v34, v35
    v_lshlrev_b32 v32, 16, v40
    v_and_b32 v33, s46, v40
    v_lshlrev_b32 v34, 16, v41
    v_and_b32 v35, s46, v41
    v_fmac_f32 v20, v32, v112
    v_fmac_f32 v21, v33, v113
    v_fmac_f32 v22, v34, v114
    v_fmac_f32 v23, v35, v115
    v_mfma_f32_16x16x32_bf16 v[28:31], a[16:19], a[16:19], 0
    v_mfma_f32_16x16x32_bf16 v[28:31], a[20:23], a[20:23], v[28:31]
    v_cvt_pk_bf16_f32 v40, v36, v37
    v_cvt_pk_bf16_f32 v41, v38, v39
    v_lshlrev_b32 v36, 16, v40
    v_and_b32 v37, s46, v40
    v_lshlrev_b32 v38, 16, v41
    v_and_b32 v39, s46, v41
    v_fmac_f32 v20, v36, v116
    v_fmac_f32 v21, v37, v117
    v_fmac_f32 v22, v38, v118
    v_fmac_f32 v23, v39, v119
    v_mfma_f32_16x16x32_bf16 v[32:35], a[16:19], a[24:27], 0
    v_mfma_f32_16x16x32_bf16 v[32:35], a[20:23], a[28:31], v[32:35]
    v_cvt_pk_bf16_f32 v40, v24, v25
    v_cvt_pk_bf16_f32 v41, v26, v27
    v_lshlrev_b32 v24, 16, v40
    v_and_b32 v25, s46, v40
    v_lshlrev_b32 v26, 16, v41
    v_and_b32 v27, s46, v41
    v_fmac_f32 v20, v24, v120
    v_fmac_f32 v21, v25, v121
    v_fmac_f32 v22, v26, v122
    v_fmac_f32 v23, v27, v123
    v_mfma_f32_16x16x32_bf16 v[36:39], a[16:19], a[32:35], 0
    v_mfma_f32_16x16x32_bf16 v[36:39], a[20:23], a[36:39], v[36:39]
    v_cvt_pk_bf16_f32 v40, v28, v29
    v_cvt_pk_bf16_f32 v41, v30, v31
    v_lshlrev_b32 v28, 16, v40
    v_and_b32 v29, s46, v40
    v_lshlrev_b32 v30, 16, v41
    v_and_b32 v31, s46, v41
    v_fmac_f32 v20, v28, v124
    v_fmac_f32 v21, v29, v125
    v_fmac_f32 v22, v30, v126
    v_fmac_f32 v23, v31, v127
    v_mfma_f32_16x16x32_bf16 v[24:27], a[16:19], a[40:43], 0
    v_mfma_f32_16x16x32_bf16 v[24:27], a[20:23], a[44:47], v[24:27]
    v_cvt_pk_bf16_f32 v40, v32, v33
    v_cvt_pk_bf16_f32 v41, v34, v35
    v_lshlrev_b32 v32, 16, v40
    v_and_b32 v33, s46, v40
    v_lshlrev_b32 v34, 16, v41
    v_and_b32 v35, s46, v41
    v_fmac_f32 v20, v32, v128
    v_fmac_f32 v21, v33, v129
    v_fmac_f32 v22, v34, v130
    v_fmac_f32 v23, v35, v131
    v_mfma_f32_16x16x32_bf16 v[28:31], a[16:19], a[48:51], 0
    v_mfma_f32_16x16x32_bf16 v[28:31], a[20:23], a[52:55], v[28:31]
    v_cvt_pk_bf16_f32 v40, v36, v37
    v_cvt_pk_bf16_f32 v41, v38, v39
    v_lshlrev_b32 v36, 16, v40
    v_and_b32 v37, s46, v40
    v_lshlrev_b32 v38, 16, v41
    v_and_b32 v39, s46, v41
    v_fmac_f32 v20, v36, v132
    v_fmac_f32 v21, v37, v133
    v_fmac_f32 v22, v38, v134
    v_fmac_f32 v23, v39, v135
    v_mfma_f32_16x16x32_bf16 v[32:35], a[24:27], a[24:27], 0
    v_mfma_f32_16x16x32_bf16 v[32:35], a[28:31], a[28:31], v[32:35]
    v_cvt_pk_bf16_f32 v40, v24, v25
    v_cvt_pk_bf16_f32 v41, v26, v27
    v_lshlrev_b32 v24, 16, v40
    v_and_b32 v25, s46, v40
    v_lshlrev_b32 v26, 16, v41
    v_and_b32 v27, s46, v41
    v_fmac_f32 v20, v24, v136
    v_fmac_f32 v21, v25, v137
    v_fmac_f32 v22, v26, v138
    v_fmac_f32 v23, v27, v139
    v_mfma_f32_16x16x32_bf16 v[36:39], a[24:27], a[32:35], 0
    v_mfma_f32_16x16x32_bf16 v[36:39], a[28:31], a[36:39], v[36:39]
    v_cvt_pk_bf16_f32 v40, v28, v29
    v_cvt_pk_bf16_f32 v41, v30, v31
    v_lshlrev_b32 v28, 16, v40
    v_and_b32 v29, s46, v40
    v_lshlrev_b32 v30, 16, v41
    v_and_b32 v31, s46, v41
    v_fmac_f32 v20, v28, v140
    v_fmac_f32 v21, v29, v141
    v_fmac_f32 v22, v30, v142
    v_fmac_f32 v23, v31, v143
    v_mfma_f32_16x16x32_bf16 v[24:27], a[24:27], a[40:43], 0
    v_mfma_f32_16x16x32_bf16 v[24:27], a[28:31], a[44:47], v[24:27]
    v_cvt_pk_bf16_f32 v40, v32, v33
    v_cvt_pk_bf16_f32 v41, v34, v35
    v_lshlrev_b32 v32, 16, v40
    v_and_b32 v33, s46, v40
    v_lshlrev_b32 v34, 16, v41
    v_and_b32 v35, s46, v41
    v_fmac_f32 v20, v32, v144
    v_fmac_f32 v21, v33, v145
    v_fmac_f32 v22, v34, v146
    v_fmac_f32 v23, v35, v147
    v_mfma_f32_16x16x32_bf16 v[28:31], a[24:27], a[48:51], 0
    v_mfma_f32_16x16x32_bf16 v[28:31], a[28:31], a[52:55], v[28:31]
    v_cvt_pk_bf16_f32 v40, v36, v37
    v_cvt_pk_bf16_f32 v41, v38, v39
    v_lshlrev_b32 v36, 16, v40
    v_and_b32 v37, s46, v40
    v_lshlrev_b32 v38, 16, v41
    v_and_b32 v39, s46, v41
    v_fmac_f32 v20, v36, v148
    v_fmac_f32 v21, v37, v149
    v_fmac_f32 v22, v38, v150
    v_fmac_f32 v23, v39, v151
    v_mfma_f32_16x16x32_bf16 v[32:35], a[32:35], a[32:35], 0
    v_mfma_f32_16x16x32_bf16 v[32:35], a[36:39], a[36:39], v[32:35]
    v_cvt_pk_bf16_f32 v40, v24, v25
    v_cvt_pk_bf16_f32 v41, v26, v27
    v_lshlrev_b32 v24, 16, v40
    v_and_b32 v25, s46, v40
    v_lshlrev_b32 v26, 16, v41
    v_and_b32 v27, s46, v41
    v_fmac_f32 v20, v24, v152
    v_fmac_f32 v21, v25, v153
    v_fmac_f32 v22, v26, v154
    v_fmac_f32 v23, v27, v155
    v_mfma_f32_16x16x32_bf16 v[36:39], a[32:35], a[40:43], 0
    v_mfma_f32_16x16x32_bf16 v[36:39], a[36:39], a[44:47], v[36:39]
    v_cvt_pk_bf16_f32 v40, v28, v29
    v_cvt_pk_bf16_f32 v41, v30, v31
    v_lshlrev_b32 v28, 16, v40
    v_and_b32 v29, s46, v40
    v_lshlrev_b32 v30, 16, v41
    v_and_b32 v31, s46, v41
    v_fmac_f32 v20, v28, v156
    v_fmac_f32 v21, v29, v157
    v_fmac_f32 v22, v30, v158
    v_fmac_f32 v23, v31, v159
    v_mfma_f32_16x16x32_bf16 v[24:27], a[32:35], a[48:51], 0
    v_mfma_f32_16x16x32_bf16 v[24:27], a[36:39], a[52:55], v[24:27]
    v_cvt_pk_bf16_f32 v40, v32, v33
    v_cvt_pk_bf16_f32 v41, v34, v35
    v_lshlrev_b32 v32, 16, v40
    v_and_b32 v33, s46, v40
    v_lshlrev_b32 v34, 16, v41
    v_and_b32 v35, s46, v41
    v_fmac_f32 v20, v32, v160
    v_fmac_f32 v21, v33, v161
    v_fmac_f32 v22, v34, v162
    v_fmac_f32 v23, v35, v163
    v_mfma_f32_16x16x32_bf16 v[28:31], a[40:43], a[40:43], 0
    v_mfma_f32_16x16x32_bf16 v[28:31], a[44:47], a[44:47], v[28:31]
    v_cvt_pk_bf16_f32 v40, v36, v37
    v_cvt_pk_bf16_f32 v41, v38, v39
    v_lshlrev_b32 v36, 16, v40
    v_and_b32 v37, s46, v40
    v_lshlrev_b32 v38, 16, v41
    v_and_b32 v39, s46, v41
    v_fmac_f32 v20, v36, v164
    v_fmac_f32 v21, v37, v165
    v_fmac_f32 v22, v38, v166
    v_fmac_f32 v23, v39, v167
    v_mfma_f32_16x16x32_bf16 v[32:35], a[40:43], a[48:51], 0
    v_mfma_f32_16x16x32_bf16 v[32:35], a[44:47], a[52:55], v[32:35]
    v_cvt_pk_bf16_f32 v40, v24, v25
    v_cvt_pk_bf16_f32 v41, v26, v27
    v_lshlrev_b32 v24, 16, v40
    v_and_b32 v25, s46, v40
    v_lshlrev_b32 v26, 16, v41
    v_and_b32 v27, s46, v41
    v_fmac_f32 v20, v24, v168
    v_fmac_f32 v21, v25, v169
    v_fmac_f32 v22, v26, v170
    v_fmac_f32 v23, v27, v171
    v_mfma_f32_16x16x32_bf16 v[36:39], a[48:51], a[48:51], 0
    v_mfma_f32_16x16x32_bf16 v[36:39], a[52:55], a[52:55], v[36:39]
    v_cvt_pk_bf16_f32 v40, v28, v29
    v_cvt_pk_bf16_f32 v41, v30, v31
    v_lshlrev_b32 v28, 16, v40
    v_and_b32 v29, s46, v40
    v_lshlrev_b32 v30, 16, v41
    v_and_b32 v31, s46, v41
    v_fmac_f32 v20, v28, v172
    v_fmac_f32 v21, v29, v173
    v_fmac_f32 v22, v30, v174
    v_fmac_f32 v23, v31, v175
    s_nop 7
    s_nop 3
    v_cvt_pk_bf16_f32 v40, v32, v33
    v_cvt_pk_bf16_f32 v41, v34, v35
    v_lshlrev_b32 v32, 16, v40
    v_and_b32 v33, s46, v40
    v_lshlrev_b32 v34, 16, v41
    v_and_b32 v35, s46, v41
    v_fmac_f32 v20, v32, v176
    v_fmac_f32 v21, v33, v177
    v_fmac_f32 v22, v34, v178
    v_fmac_f32 v23, v35, v179
    v_cvt_pk_bf16_f32 v40, v36, v37
    v_cvt_pk_bf16_f32 v41, v38, v39
    v_lshlrev_b32 v36, 16, v40
    v_and_b32 v37, s46, v40
    v_lshlrev_b32 v38, 16, v41
    v_and_b32 v39, s46, v41
    v_fmac_f32 v20, v36, v180
    v_fmac_f32 v21, v37, v181
    v_fmac_f32 v22, v38, v182
    v_fmac_f32 v23, v39, v183
    v_add_f32 v20, v20, v21
    v_add_f32 v22, v22, v23
    v_add_f32 v2, v20, v22
    s_nop 1
    v_add_f32_dpp v2, v2, v2 row_shr:1 row_mask:0xf bank_mask:0xf bound_ctrl:0
    s_nop 1
    v_add_f32_dpp v2, v2, v2 row_shr:2 row_mask:0xf bank_mask:0xf bound_ctrl:0
    s_nop 1
    v_add_f32_dpp v2, v2, v2 row_shr:4 row_mask:0xf bank_mask:0xf bound_ctrl:0
    s_nop 1
    v_add_f32_dpp v2, v2, v2 row_shr:8 row_mask:0xf bank_mask:0xf bound_ctrl:0
    s_nop 1
    v_readlane_b32 s52, v2, 15
    v_readlane_b32 s53, v2, 31
    v_readlane_b32 s54, v2, 47
    v_readlane_b32 s55, v2, 63
    s_nop 3
    v_mov_b32 v2, s52
    v_add_f32 v2, s53, v2
    v_add_f32 v2, s54, v2
    v_add_f32 v2, s55, v2
    v_mov_b32 v3, s50
    s_mov_b64 exec, 1
    global_store_dword v3, v2, s[22:23] sc1
    s_mov_b64 exec, -1
    s_add_u32 s50, s50, 4
    s_add_u32 s48, s48, 1
    s_cmp_lt_u32 s48, 4
    s_cbranch_scc1 L_pnn
    s_barrier
    s_barrier
    s_waitcnt vmcnt(0)
    s_barrier
    s_branch L_end
L_mlprole:
    s_barrier
    s_mul_i32 s33, s24, 819200
    s_lshl_b32 s34, s26, 6
    s_add_u32 s33, s33, s34
    s_add_u32 s56, s10, s33
    s_addc_u32 s57, s11, 0
    s_mov_b32 s47, 0
    s_add_u32 m0, s30, 0
    s_add_u32 s40, s56, s47
    s_addc_u32 s41, s57, 0
    global_load_lds_dwordx4 v10, s[40:41]
    s_add_u32 s47, s47, 8192
    s_min_u32 s47, s47, 811008
    s_add_u32 m0, s30, 1024
    s_add_u32 s40, s56, s47
    s_addc_u32 s41, s57, 0
    global_load_lds_dwordx4 v10, s[40:41]
    s_add_u32 s47, s47, 8192
    s_min_u32 s47, s47, 811008
    s_add_u32 m0, s30, 2048
    s_add_u32 s40, s56, s47
    s_addc_u32 s41, s57, 0
    global_load_lds_dwordx4 v10, s[40:41]
    s_add_u32 s47, s47, 8192
    s_min_u32 s47, s47, 811008
    s_add_u32 m0, s30, 3072
    s_add_u32 s40, s56, s47
    s_addc_u32 s41, s57, 0
    global_load_lds_dwordx4 v10, s[40:41]
    s_add_u32 s47, s47, 8192
    s_min_u32 s47, s47, 811008
    s_add_u32 m0, s30, 4096
    s_add_u32 s40, s56, s47
    s_addc_u32 s41, s57, 0
    global_load_lds_dwordx4 v10, s[40:41]
    s_add_u32 s47, s47, 8192
    s_min_u32 s47, s47, 811008
    s_add_u32 m0, s30, 5120
    s_add_u32 s40, s56, s47
    s_addc_u32 s41, s57, 0
    global_load_lds_dwordx4 v10, s[40:41]
    s_add_u32 s47, s47, 8192
    s_min_u32 s47, s47, 811008
    v_accvgpr_write_b32 a0, 0
    v_accvgpr_write_b32 a1, 0
    v_accvgpr_write_b32 a2, 0
    v_accvgpr_write_b32 a3, 0
    v_accvgpr_write_b32 a4, 0
    v_accvgpr_write_b32 a5, 0
    v_accvgpr_write_b32 a6, 0
    v_accvgpr_write_b32 a7, 0
    v_accvgpr_write_b32 a8, 0
    v_accvgpr_write_b32 a9, 0
    v_accvgpr_write_b32 a10, 0
    v_accvgpr_write_b32 a11, 0
    v_accvgpr_write_b32 a12, 0
    v_accvgpr_write_b32 a13, 0
    v_accvgpr_write_b32 a14, 0
    v_accvgpr_write_b32 a15, 0
    v_accvgpr_write_b32 a16, 0
    v_accvgpr_write_b32 a17, 0
    v_accvgpr_write_b32 a18, 0
    v_accvgpr_write_b32 a19, 0
    v_accvgpr_write_b32 a20, 0
    v_accvgpr_write_b32 a21, 0
    v_accvgpr_write_b32 a22, 0
    v_accvgpr_write_b32 a23, 0
    v_accvgpr_write_b32 a24, 0
    v_accvgpr_write_b32 a25, 0
    v_accvgpr_write_b32 a26, 0
    v_accvgpr_write_b32 a27, 0
    v_accvgpr_write_b32 a28, 0
    v_accvgpr_write_b32 a29, 0
    v_accvgpr_write_b32 a30, 0
    v_accvgpr_write_b32 a31, 0
    v_accvgpr_write_b32 a32, 0
    v_accvgpr_write_b32 a33, 0
    v_accvgpr_write_b32 a34, 0
    v_accvgpr_write_b32 a35, 0
    v_accvgpr_write_b32 a36, 0
    v_accvgpr_write_b32 a37, 0
    v_accvgpr_write_b32 a38, 0
    v_accvgpr_write_b32 a39, 0
    v_accvgpr_write_b32 a40, 0
    v_accvgpr_write_b32 a41, 0
    v_accvgpr_write_b32 a42, 0
    v_accvgpr_write_b32 a43, 0
    v_accvgpr_write_b32 a44, 0
    v_accvgpr_write_b32 a45, 0
    v_accvgpr_write_b32 a46, 0
    v_accvgpr_write_b32 a47, 0
    v_accvgpr_write_b32 a48, 0
    v_accvgpr_write_b32 a49, 0
    v_accvgpr_write_b32 a50, 0
    v_accvgpr_write_b32 a51, 0
    v_accvgpr_write_b32 a52, 0
    v_accvgpr_write_b32 a53, 0
    v_accvgpr_write_b32 a54, 0
    v_accvgpr_write_b32 a55, 0
    v_accvgpr_write_b32 a56, 0
    v_accvgpr_write_b32 a57, 0
    v_accvgpr_write_b32 a58, 0
    v_accvgpr_write_b32 a59, 0
    v_accvgpr_write_b32 a60, 0
    v_accvgpr_write_b32 a61, 0
    v_accvgpr_write_b32 a62, 0
    v_accvgpr_write_b32 a63, 0
    s_mov_b32 s49, 0
    global_load_dwordx4 v[116:119], v14, s[4:5]
    global_load_dwordx4 v[120:123], v15, s[4:5]
    global_load_dwordx4 v[124:127], v16, s[4:5]
    global_load_dwordx4 v[128:131], v17, s[4:5]
    s_add_u32 s49, s49, 1
    s_cmp_lt_u32 s49, 6
    s_cselect_b32 s51, 16, 4
    s_cmp_lt_u32 s49, 7
    s_cselect_b32 s51, s51, 0
    v_add_u32 v14, s51, v14
    v_add_u32 v15, s51, v15
    v_add_u32 v16, s51, v16
    v_add_u32 v17, s51, v17
    s_waitcnt vmcnt(0)
    v_mov_b32 v100, v116
    v_mov_b32 v101, v117
    v_mov_b32 v102, v118
    v_mov_b32 v103, v119
    v_mov_b32 v104, v120
    v_mov_b32 v105, v121
    v_mov_b32 v106, v122
    v_mov_b32 v107, v123
    v_mov_b32 v108, v124
    v_mov_b32 v109, v125
    v_mov_b32 v110, v126
    v_mov_b32 v111, v127
    v_mov_b32 v112, v128
    v_mov_b32 v113, v129
    v_mov_b32 v114, v130
    v_mov_b32 v115, v131
    global_load_dwordx4 v[116:119], v14, s[4:5]
    global_load_dwordx4 v[120:123], v15, s[4:5]
    global_load_dwordx4 v[124:127], v16, s[4:5]
    global_load_dwordx4 v[128:131], v17, s[4:5]
    s_add_u32 s49, s49, 1
    s_cmp_lt_u32 s49, 6
    s_cselect_b32 s51, 16, 4
    s_cmp_lt_u32 s49, 7
    s_cselect_b32 s51, s51, 0
    v_add_u32 v14, s51, v14
    v_add_u32 v15, s51, v15
    v_add_u32 v16, s51, v16
    v_add_u32 v17, s51, v17
    v_bfe_u32 v2, v100, 1, 3
    v_lshlrev_b32 v3, 7, v100
    v_lshl_or_b32 v2, v2, 4, v3
    v_xor_b32 v42, v2, v12
    v_xor_b32 v43, 32, v42
    v_xor_b32 v44, 64, v42
    v_xor_b32 v45, 96, v42
    v_bfe_u32 v2, v104, 1, 3
    v_lshlrev_b32 v3, 7, v104
    v_lshl_or_b32 v2, v2, 4, v3
    v_xor_b32 v46, v2, v12
    v_xor_b32 v47, 32, v46
    v_xor_b32 v48, 64, v46
    v_xor_b32 v49, 96, v46
    v_bfe_u32 v2, v108, 1, 3
    v_lshlrev_b32 v3, 7, v108
    v_lshl_or_b32 v2, v2, 4, v3
    v_xor_b32 v50, v2, v12
    v_xor_b32 v51, 32, v50
    v_xor_b32 v52, 64, v50
    v_xor_b32 v53, 96, v50
    v_bfe_u32 v2, v112, 1, 3
    v_lshlrev_b32 v3, 7, v112
    v_lshl_or_b32 v2, v2, 4, v3
    v_xor_b32 v54, v2, v12
    v_xor_b32 v55, 32, v54
    v_xor_b32 v56, 64, v54
    v_xor_b32 v57, 96, v54
    s_waitcnt vmcnt(13)
    ds_read_b64_tr_b16 v[92:93], v11 offset:0
    ds_read_b64_tr_b16 v[94:95], v11 offset:256
    ds_read_b128 v[60:63], v42
    ds_read_b128 v[64:67], v46
    ds_read_b128 v[68:71], v50
    ds_read_b128 v[72:75], v54
    s_add_u32 m0, s30, 6144
    s_add_u32 s40, s56, s47
    s_addc_u32 s41, s57, 0
    global_load_lds_dwordx4 v10, s[40:41]
    s_add_u32 s47, s47, 8192
    s_min_u32 s47, s47, 811008
    s_mov_b32 s58, 0
L_mlp:
    s_waitcnt vmcnt(9)
    ds_read_b64_tr_b16 v[96:97], v11 offset:1024
    ds_read_b64_tr_b16 v[98:99], v11 offset:1280
    ds_read_b128 v[76:79], v43
    ds_read_b128 v[80:83], v47
    ds_read_b128 v[84:87], v51
    ds_read_b128 v[88:91], v55
    s_waitcnt lgkmcnt(6)
    v_mfma_f32_32x32x16_bf16 a[0:15], v[92:95], v[60:63], a[0:15]
    v_mfma_f32_32x32x16_bf16 a[16:31], v[92:95], v[64:67], a[16:31]
    v_mfma_f32_32x32x16_bf16 a[32:47], v[92:95], v[68:71], a[32:47]
    v_mfma_f32_32x32x16_bf16 a[48:63], v[92:95], v[72:75], a[48:63]
    s_add_u32 m0, s30, 7168
    s_add_u32 s40, s56, s47
    s_addc_u32 s41, s57, 0
    global_load_lds_dwordx4 v10, s[40:41]
    s_add_u32 s47, s47, 8192
    s_min_u32 s47, s47, 811008
    s_waitcnt vmcnt(9)
    ds_read_b64_tr_b16 v[92:93], v11 offset:2048
    ds_read_b64_tr_b16 v[94:95], v11 offset:2304
    ds_read_b128 v[60:63], v44
    ds_read_b128 v[64:67], v48
    ds_read_b128 v[68:71], v52
    ds_read_b128 v[72:75], v56
    s_waitcnt lgkmcnt(6)
    v_mfma_f32_32x32x16_bf16 a[0:15], v[96:99], v[76:79], a[0:15]
    v_mfma_f32_32x32x16_bf16 a[16:31], v[96:99], v[80:83], a[16:31]
    v_mfma_f32_32x32x16_bf16 a[32:47], v[96:99], v[84:87], a[32:47]
    v_mfma_f32_32x32x16_bf16 a[48:63], v[96:99], v[88:91], a[48:63]
    s_add_u32 m0, s30, 0
    s_add_u32 s40, s56, s47
    s_addc_u32 s41, s57, 0
    global_load_lds_dwordx4 v10, s[40:41]
    s_add_u32 s47, s47, 8192
    s_min_u32 s47, s47, 811008
    s_waitcnt vmcnt(9)
    ds_read_b64_tr_b16 v[96:97], v11 offset:3072
    ds_read_b64_tr_b16 v[98:99], v11 offset:3328
    ds_read_b128 v[76:79], v45
    ds_read_b128 v[80:83], v49
    ds_read_b128 v[84:87], v53
    ds_read_b128 v[88:91], v57
    s_waitcnt lgkmcnt(6)
    v_mfma_f32_32x32x16_bf16 a[0:15], v[92:95], v[60:63], a[0:15]
    v_mfma_f32_32x32x16_bf16 a[16:31], v[92:95], v[64:67], a[16:31]
    v_mfma_f32_32x32x16_bf16 a[32:47], v[92:95], v[68:71], a[32:47]
    v_mfma_f32_32x32x16_bf16 a[48:63], v[92:95], v[72:75], a[48:63]
    s_add_u32 m0, s30, 1024
    s_add_u32 s40, s56, s47
    s_addc_u32 s41, s57, 0
    global_load_lds_dwordx4 v10, s[40:41]
    s_add_u32 s47, s47, 8192
    s_min_u32 s47, s47, 811008
    v_bfe_u32 v2, v101, 1, 3
    v_lshlrev_b32 v3, 7, v101
    v_lshl_or_b32 v2, v2, 4, v3
    v_xor_b32 v42, v2, v12
    v_xor_b32 v43, 32, v42
    v_xor_b32 v44, 64, v42
    v_xor_b32 v45, 96, v42
    v_bfe_u32 v2, v105, 1, 3
    v_lshlrev_b32 v3, 7, v105
    v_lshl_or_b32 v2, v2, 4, v3
    v_xor_b32 v46, v2, v12
    v_xor_b32 v47, 32, v46
    v_xor_b32 v48, 64, v46
    v_xor_b32 v49, 96, v46
    v_bfe_u32 v2, v109, 1, 3
    v_lshlrev_b32 v3, 7, v109
    v_lshl_or_b32 v2, v2, 4, v3
    v_xor_b32 v50, v2, v12
    v_xor_b32 v51, 32, v50
    v_xor_b32 v52, 64, v50
    v_xor_b32 v53, 96, v50
    v_bfe_u32 v2, v113, 1, 3
    v_lshlrev_b32 v3, 7, v113
    v_lshl_or_b32 v2, v2, 4, v3
    v_xor_b32 v54, v2, v12
    v_xor_b32 v55, 32, v54
    v_xor_b32 v56, 64, v54
    v_xor_b32 v57, 96, v54
    s_waitcnt vmcnt(9)
    ds_read_b64_tr_b16 v[92:93], v11 offset:4096
    ds_read_b64_tr_b16 v[94:95], v11 offset:4352
    ds_read_b128 v[60:63], v42
    ds_read_b128 v[64:67], v46
    ds_read_b128 v[68:71], v50
    ds_read_b128 v[72:75], v54
    s_waitcnt lgkmcnt(6)
    v_mfma_f32_32x32x16_bf16 a[0:15], v[96:99], v[76:79], a[0:15]
    v_mfma_f32_32x32x16_bf16 a[16:31], v[96:99], v[80:83], a[16:31]
    v_mfma_f32_32x32x16_bf16 a[32:47], v[96:99], v[84:87], a[32:47]
    v_mfma_f32_32x32x16_bf16 a[48:63], v[96:99], v[88:91], a[48:63]
    s_add_u32 m0, s30, 2048
    s_add_u32 s40, s56, s47
    s_addc_u32 s41, s57, 0
    global_load_lds_dwordx4 v10, s[40:41]
    s_add_u32 s47, s47, 8192
    s_min_u32 s47, s47, 811008
    s_waitcnt vmcnt(9)
    ds_read_b64_tr_b16 v[96:97], v11 offset:5120
    ds_read_b64_tr_b16 v[98:99], v11 offset:5376
    ds_read_b128 v[76:79], v43
    ds_read_b128 v[80:83], v47
    ds_read_b128 v[84:87], v51
    ds_read_b128 v[88:91], v55
    s_waitcnt lgkmcnt(6)
    v_mfma_f32_32x32x16_bf16 a[0:15], v[92:95], v[60:63], a[0:15]
    v_mfma_f32_32x32x16_bf16 a[16:31], v[92:95], v[64:67], a[16:31]
    v_mfma_f32_32x32x16_bf16 a[32:47], v[92:95], v[68:71], a[32:47]
    v_mfma_f32_32x32x16_bf16 a[48:63], v[92:95], v[72:75], a[48:63]
    s_add_u32 m0, s30, 3072
    s_add_u32 s40, s56, s47
    s_addc_u32 s41, s57, 0
    global_load_lds_dwordx4 v10, s[40:41]
    s_add_u32 s47, s47, 8192
    s_min_u32 s47, s47, 811008
    s_waitcnt vmcnt(5)
    ds_read_b64_tr_b16 v[92:93], v11 offset:6144
    ds_read_b64_tr_b16 v[94:95], v11 offset:6400
    ds_read_b128 v[60:63], v44
    ds_read_b128 v[64:67], v48
    ds_read_b128 v[68:71], v52
    ds_read_b128 v[72:75], v56
    s_waitcnt lgkmcnt(6)
    v_mfma_f32_32x32x16_bf16 a[0:15], v[96:99], v[76:79], a[0:15]
    v_mfma_f32_32x32x16_bf16 a[16:31], v[96:99], v[80:83], a[16:31]
    v_mfma_f32_32x32x16_bf16 a[32:47], v[96:99], v[84:87], a[32:47]
    v_mfma_f32_32x32x16_bf16 a[48:63], v[96:99], v[88:91], a[48:63]
    s_add_u32 m0, s30, 4096
    s_add_u32 s40, s56, s47
    s_addc_u32 s41, s57, 0
    global_load_lds_dwordx4 v10, s[40:41]
    s_add_u32 s47, s47, 8192
    s_min_u32 s47, s47, 811008
    s_waitcnt vmcnt(5)
    ds_read_b64_tr_b16 v[96:97], v11 offset:7168
    ds_read_b64_tr_b16 v[98:99], v11 offset:7424
    ds_read_b128 v[76:79], v45
    ds_read_b128 v[80:83], v49
    ds_read_b128 v[84:87], v53
    ds_read_b128 v[88:91], v57
    s_waitcnt lgkmcnt(6)
    v_mfma_f32_32x32x16_bf16 a[0:15], v[92:95], v[60:63], a[0:15]
    v_mfma_f32_32x32x16_bf16 a[16:31], v[92:95], v[64:67], a[16:31]
    v_mfma_f32_32x32x16_bf16 a[32:47], v[92:95], v[68:71], a[32:47]
    v_mfma_f32_32x32x16_bf16 a[48:63], v[92:95], v[72:75], a[48:63]
    s_add_u32 m0, s30, 5120
    s_add_u32 s40, s56, s47
    s_addc_u32 s41, s57, 0
    global_load_lds_dwordx4 v10, s[40:41]
    s_add_u32 s47, s47, 8192
    s_min_u32 s47, s47, 811008
    v_bfe_u32 v2, v102, 1, 3
    v_lshlrev_b32 v3, 7, v102
    v_lshl_or_b32 v2, v2, 4, v3
    v_xor_b32 v42, v2, v12
    v_xor_b32 v43, 32, v42
    v_xor_b32 v44, 64, v42
    v_xor_b32 v45, 96, v42
    v_bfe_u32 v2, v106, 1, 3
    v_lshlrev_b32 v3, 7, v106
    v_lshl_or_b32 v2, v2, 4, v3
    v_xor_b32 v46, v2, v12
    v_xor_b32 v47, 32, v46
    v_xor_b32 v48, 64, v46
    v_xor_b32 v49, 96, v46
    v_bfe_u32 v2, v110, 1, 3
    v_lshlrev_b32 v3, 7, v110
    v_lshl_or_b32 v2, v2, 4, v3
    v_xor_b32 v50, v2, v12
    v_xor_b32 v51, 32, v50
    v_xor_b32 v52, 64, v50
    v_xor_b32 v53, 96, v50
    v_bfe_u32 v2, v114, 1, 3
    v_lshlrev_b32 v3, 7, v114
    v_lshl_or_b32 v2, v2, 4, v3
    v_xor_b32 v54, v2, v12
    v_xor_b32 v55, 32, v54
    v_xor_b32 v56, 64, v54
    v_xor_b32 v57, 96, v54
    s_waitcnt vmcnt(5)
    ds_read_b64_tr_b16 v[92:93], v11 offset:0
    ds_read_b64_tr_b16 v[94:95], v11 offset:256
    ds_read_b128 v[60:63], v42
    ds_read_b128 v[64:67], v46
    ds_read_b128 v[68:71], v50
    ds_read_b128 v[72:75], v54
    s_waitcnt lgkmcnt(6)
    v_mfma_f32_32x32x16_bf16 a[0:15], v[96:99], v[76:79], a[0:15]
    v_mfma_f32_32x32x16_bf16 a[16:31], v[96:99], v[80:83], a[16:31]
    v_mfma_f32_32x32x16_bf16 a[32:47], v[96:99], v[84:87], a[32:47]
    v_mfma_f32_32x32x16_bf16 a[48:63], v[96:99], v[88:91], a[48:63]
    s_add_u32 m0, s30, 6144
    s_add_u32 s40, s56, s47
    s_addc_u32 s41, s57, 0
    global_load_lds_dwordx4 v10, s[40:41]
    s_add_u32 s47, s47, 8192
    s_min_u32 s47, s47, 811008
    s_waitcnt vmcnt(5)
    ds_read_b64_tr_b16 v[96:97], v11 offset:1024
    ds_read_b64_tr_b16 v[98:99], v11 offset:1280
    ds_read_b128 v[76:79], v43
    ds_read_b128 v[80:83], v47
    ds_read_b128 v[84:87], v51
    ds_read_b128 v[88:91], v55
    s_waitcnt lgkmcnt(6)
    v_mfma_f32_32x32x16_bf16 a[0:15], v[92:95], v[60:63], a[0:15]
    v_mfma_f32_32x32x16_bf16 a[16:31], v[92:95], v[64:67], a[16:31]
    v_mfma_f32_32x32x16_bf16 a[32:47], v[92:95], v[68:71], a[32:47]
    v_mfma_f32_32x32x16_bf16 a[48:63], v[92:95], v[72:75], a[48:63]
    s_add_u32 m0, s30, 7168
    s_add_u32 s40, s56, s47
    s_addc_u32 s41, s57, 0
    global_load_lds_dwordx4 v10, s[40:41]
    s_add_u32 s47, s47, 8192
    s_min_u32 s47, s47, 811008
    s_waitcnt vmcnt(5)
    ds_read_b64_tr_b16 v[92:93], v11 offset:2048
    ds_read_b64_tr_b16 v[94:95], v11 offset:2304
    ds_read_b128 v[60:63], v44
    ds_read_b128 v[64:67], v48
    ds_read_b128 v[68:71], v52
    ds_read_b128 v[72:75], v56
    s_waitcnt lgkmcnt(6)
    v_mfma_f32_32x32x16_bf16 a[0:15], v[96:99], v[76:79], a[0:15]
    v_mfma_f32_32x32x16_bf16 a[16:31], v[96:99], v[80:83], a[16:31]
    v_mfma_f32_32x32x16_bf16 a[32:47], v[96:99], v[84:87], a[32:47]
    v_mfma_f32_32x32x16_bf16 a[48:63], v[96:99], v[88:91], a[48:63]
    s_add_u32 m0, s30, 0
    s_add_u32 s40, s56, s47
    s_addc_u32 s41, s57, 0
    global_load_lds_dwordx4 v10, s[40:41]
    s_add_u32 s47, s47, 8192
    s_min_u32 s47, s47, 811008
    s_waitcnt vmcnt(5)
    ds_read_b64_tr_b16 v[96:97], v11 offset:3072
    ds_read_b64_tr_b16 v[98:99], v11 offset:3328
    ds_read_b128 v[76:79], v45
    ds_read_b128 v[80:83], v49
    ds_read_b128 v[84:87], v53
    ds_read_b128 v[88:91], v57
    s_waitcnt lgkmcnt(6)
    v_mfma_f32_32x32x16_bf16 a[0:15], v[92:95], v[60:63], a[0:15]
    v_mfma_f32_32x32x16_bf16 a[16:31], v[92:95], v[64:67], a[16:31]
    v_mfma_f32_32x32x16_bf16 a[32:47], v[92:95], v[68:71], a[32:47]
    v_mfma_f32_32x32x16_bf16 a[48:63], v[92:95], v[72:75], a[48:63]
    s_add_u32 m0, s30, 1024
    s_add_u32 s40, s56, s47
    s_addc_u32 s41, s57, 0
    global_load_lds_dwordx4 v10, s[40:41]
    s_add_u32 s47, s47, 8192
    s_min_u32 s47, s47, 811008
    v_bfe_u32 v2, v103, 1, 3
    v_lshlrev_b32 v3, 7, v103
    v_lshl_or_b32 v2, v2, 4, v3
    v_xor_b32 v42, v2, v12
    v_xor_b32 v43, 32, v42
    v_xor_b32 v44, 64, v42
    v_xor_b32 v45, 96, v42
    v_bfe_u32 v2, v107, 1, 3
    v_lshlrev_b32 v3, 7, v107
    v_lshl_or_b32 v2, v2, 4, v3
    v_xor_b32 v46, v2, v12
    v_xor_b32 v47, 32, v46
    v_xor_b32 v48, 64, v46
    v_xor_b32 v49, 96, v46
    v_bfe_u32 v2, v111, 1, 3
    v_lshlrev_b32 v3, 7, v111
    v_lshl_or_b32 v2, v2, 4, v3
    v_xor_b32 v50, v2, v12
    v_xor_b32 v51, 32, v50
    v_xor_b32 v52, 64, v50
    v_xor_b32 v53, 96, v50
    v_bfe_u32 v2, v115, 1, 3
    v_lshlrev_b32 v3, 7, v115
    v_lshl_or_b32 v2, v2, 4, v3
    v_xor_b32 v54, v2, v12
    v_xor_b32 v55, 32, v54
    v_xor_b32 v56, 64, v54
    v_xor_b32 v57, 96, v54
    s_waitcnt vmcnt(5)
    ds_read_b64_tr_b16 v[92:93], v11 offset:4096
    ds_read_b64_tr_b16 v[94:95], v11 offset:4352
    ds_read_b128 v[60:63], v42
    ds_read_b128 v[64:67], v46
    ds_read_b128 v[68:71], v50
    ds_read_b128 v[72:75], v54
    s_waitcnt lgkmcnt(6)
    v_mfma_f32_32x32x16_bf16 a[0:15], v[96:99], v[76:79], a[0:15]
    v_mfma_f32_32x32x16_bf16 a[16:31], v[96:99], v[80:83], a[16:31]
    v_mfma_f32_32x32x16_bf16 a[32:47], v[96:99], v[84:87], a[32:47]
    v_mfma_f32_32x32x16_bf16 a[48:63], v[96:99], v[88:91], a[48:63]
    s_add_u32 m0, s30, 2048
    s_add_u32 s40, s56, s47
    s_addc_u32 s41, s57, 0
    global_load_lds_dwordx4 v10, s[40:41]
    s_add_u32 s47, s47, 8192
    s_min_u32 s47, s47, 811008
    s_waitcnt vmcnt(5)
    ds_read_b64_tr_b16 v[96:97], v11 offset:5120
    ds_read_b64_tr_b16 v[98:99], v11 offset:5376
    ds_read_b128 v[76:79], v43
    ds_read_b128 v[80:83], v47
    ds_read_b128 v[84:87], v51
    ds_read_b128 v[88:91], v55
    s_waitcnt lgkmcnt(6)
    v_mfma_f32_32x32x16_bf16 a[0:15], v[92:95], v[60:63], a[0:15]
    v_mfma_f32_32x32x16_bf16 a[16:31], v[92:95], v[64:67], a[16:31]
    v_mfma_f32_32x32x16_bf16 a[32:47], v[92:95], v[68:71], a[32:47]
    v_mfma_f32_32x32x16_bf16 a[48:63], v[92:95], v[72:75], a[48:63]
    s_add_u32 m0, s30, 3072
    s_add_u32 s40, s56, s47
    s_addc_u32 s41, s57, 0
    global_load_lds_dwordx4 v10, s[40:41]
    s_add_u32 s47, s47, 8192
    s_min_u32 s47, s47, 811008
    s_waitcnt vmcnt(5)
    ds_read_b64_tr_b16 v[92:93], v11 offset:6144
    ds_read_b64_tr_b16 v[94:95], v11 offset:6400
    ds_read_b128 v[60:63], v44
    ds_read_b128 v[64:67], v48
    ds_read_b128 v[68:71], v52
    ds_read_b128 v[72:75], v56
    s_waitcnt lgkmcnt(6)
    v_mfma_f32_32x32x16_bf16 a[0:15], v[96:99], v[76:79], a[0:15]
    v_mfma_f32_32x32x16_bf16 a[16:31], v[96:99], v[80:83], a[16:31]
    v_mfma_f32_32x32x16_bf16 a[32:47], v[96:99], v[84:87], a[32:47]
    v_mfma_f32_32x32x16_bf16 a[48:63], v[96:99], v[88:91], a[48:63]
    s_add_u32 m0, s30, 4096
    s_add_u32 s40, s56, s47
    s_addc_u32 s41, s57, 0
    global_load_lds_dwordx4 v10, s[40:41]
    s_add_u32 s47, s47, 8192
    s_min_u32 s47, s47, 811008
    s_waitcnt vmcnt(5)
    ds_read_b64_tr_b16 v[96:97], v11 offset:7168
    ds_read_b64_tr_b16 v[98:99], v11 offset:7424
    ds_read_b128 v[76:79], v45
    ds_read_b128 v[80:83], v49
    ds_read_b128 v[84:87], v53
    ds_read_b128 v[88:91], v57
    s_waitcnt lgkmcnt(6)
    v_mfma_f32_32x32x16_bf16 a[0:15], v[92:95], v[60:63], a[0:15]
    v_mfma_f32_32x32x16_bf16 a[16:31], v[92:95], v[64:67], a[16:31]
    v_mfma_f32_32x32x16_bf16 a[32:47], v[92:95], v[68:71], a[32:47]
    v_mfma_f32_32x32x16_bf16 a[48:63], v[92:95], v[72:75], a[48:63]
    s_add_u32 m0, s30, 5120
    s_add_u32 s40, s56, s47
    s_addc_u32 s41, s57, 0
    global_load_lds_dwordx4 v10, s[40:41]
    s_add_u32 s47, s47, 8192
    s_min_u32 s47, s47, 811008
    s_waitcnt vmcnt(16)
    v_mov_b32 v100, v116
    v_mov_b32 v101, v117
    v_mov_b32 v102, v118
    v_mov_b32 v103, v119
    v_mov_b32 v104, v120
    v_mov_b32 v105, v121
    v_mov_b32 v106, v122
    v_mov_b32 v107, v123
    v_mov_b32 v108, v124
    v_mov_b32 v109, v125
    v_mov_b32 v110, v126
    v_mov_b32 v111, v127
    v_mov_b32 v112, v128
    v_mov_b32 v113, v129
    v_mov_b32 v114, v130
    v_mov_b32 v115, v131
    global_load_dwordx4 v[116:119], v14, s[4:5]
    global_load_dwordx4 v[120:123], v15, s[4:5]
    global_load_dwordx4 v[124:127], v16, s[4:5]
    global_load_dwordx4 v[128:131], v17, s[4:5]
    s_add_u32 s49, s49, 1
    s_cmp_lt_u32 s49, 6
    s_cselect_b32 s51, 16, 4
    s_cmp_lt_u32 s49, 7
    s_cselect_b32 s51, s51, 0
    v_add_u32 v14, s51, v14
    v_add_u32 v15, s51, v15
    v_add_u32 v16, s51, v16
    v_add_u32 v17, s51, v17
    v_bfe_u32 v2, v100, 1, 3
    v_lshlrev_b32 v3, 7, v100
    v_lshl_or_b32 v2, v2, 4, v3
    v_xor_b32 v42, v2, v12
    v_xor_b32 v43, 32, v42
    v_xor_b32 v44, 64, v42
    v_xor_b32 v45, 96, v42
    v_bfe_u32 v2, v104, 1, 3
    v_lshlrev_b32 v3, 7, v104
    v_lshl_or_b32 v2, v2, 4, v3
    v_xor_b32 v46, v2, v12
    v_xor_b32 v47, 32, v46
    v_xor_b32 v48, 64, v46
    v_xor_b32 v49, 96, v46
    v_bfe_u32 v2, v108, 1, 3
    v_lshlrev_b32 v3, 7, v108
    v_lshl_or_b32 v2, v2, 4, v3
    v_xor_b32 v50, v2, v12
    v_xor_b32 v51, 32, v50
    v_xor_b32 v52, 64, v50
    v_xor_b32 v53, 96, v50
    v_bfe_u32 v2, v112, 1, 3
    v_lshlrev_b32 v3, 7, v112
    v_lshl_or_b32 v2, v2, 4, v3
    v_xor_b32 v54, v2, v12
    v_xor_b32 v55, 32, v54
    v_xor_b32 v56, 64, v54
    v_xor_b32 v57, 96, v54
    s_waitcnt vmcnt(9)
    ds_read_b64_tr_b16 v[92:93], v11 offset:0
    ds_read_b64_tr_b16 v[94:95], v11 offset:256
    ds_read_b128 v[60:63], v42
    ds_read_b128 v[64:67], v46
    ds_read_b128 v[68:71], v50
    ds_read_b128 v[72:75], v54
    s_waitcnt lgkmcnt(6)
    v_mfma_f32_32x32x16_bf16 a[0:15], v[96:99], v[76:79], a[0:15]
    v_mfma_f32_32x32x16_bf16 a[16:31], v[96:99], v[80:83], a[16:31]
    v_mfma_f32_32x32x16_bf16 a[32:47], v[96:99], v[84:87], a[32:47]
    v_mfma_f32_32x32x16_bf16 a[48:63], v[96:99], v[88:91], a[48:63]
    s_add_u32 m0, s30, 6144
    s_add_u32 s40, s56, s47
    s_addc_u32 s41, s57, 0
    global_load_lds_dwordx4 v10, s[40:41]
    s_add_u32 s47, s47, 8192
    s_min_u32 s47, s47, 811008
    s_add_u32 s58, s58, 1
    s_cmp_lt_u32 s58, 6
    s_cbranch_scc1 L_mlp
    s_waitcnt lgkmcnt(0)
    v_bfe_u32 v2, v103, 1, 3
    v_lshlrev_b32 v3, 7, v103
    v_lshl_or_b32 v2, v2, 4, v3
    v_xor_b32 v42, v2, v12
    v_xor_b32 v43, 32, v42
    v_xor_b32 v44, 64, v42
    v_xor_b32 v45, 96, v42
    v_bfe_u32 v2, v107, 1, 3
    v_lshlrev_b32 v3, 7, v107
    v_lshl_or_b32 v2, v2, 4, v3
    v_xor_b32 v46, v2, v12
    v_xor_b32 v47, 32, v46
    v_xor_b32 v48, 64, v46
    v_xor_b32 v49, 96, v46
    v_bfe_u32 v2, v111, 1, 3
    v_lshlrev_b32 v3, 7, v111
    v_lshl_or_b32 v2, v2, 4, v3
    v_xor_b32 v50, v2, v12
    v_xor_b32 v51, 32, v50
    v_xor_b32 v52, 64, v50
    v_xor_b32 v53, 96, v50
    v_bfe_u32 v2, v115, 1, 3
    v_lshlrev_b32 v3, 7, v115
    v_lshl_or_b32 v2, v2, 4, v3
    v_xor_b32 v54, v2, v12
    v_xor_b32 v55, 32, v54
    v_xor_b32 v56, 64, v54
    v_xor_b32 v57, 96, v54
    ds_read_b128 v[60:63], v42
    ds_read_b128 v[64:67], v46
    ds_read_b128 v[68:71], v50
    ds_read_b128 v[72:75], v54
    s_waitcnt vmcnt(9)
    ds_read_b64_tr_b16 v[96:97], v11 offset:1024
    ds_read_b64_tr_b16 v[98:99], v11 offset:1280
    ds_read_b128 v[76:79], v43
    ds_read_b128 v[80:83], v47
    ds_read_b128 v[84:87], v51
    ds_read_b128 v[88:91], v55
    s_waitcnt lgkmcnt(6)
    v_mfma_f32_32x32x16_bf16 a[0:15], v[92:95], v[60:63], a[0:15]
    v_mfma_f32_32x32x16_bf16 a[16:31], v[92:95], v[64:67], a[16:31]
    v_mfma_f32_32x32x16_bf16 a[32:47], v[92:95], v[68:71], a[32:47]
    v_mfma_f32_32x32x16_bf16 a[48:63], v[92:95], v[72:75], a[48:63]
    s_add_u32 m0, s30, 7168
    s_add_u32 s40, s56, s47
    s_addc_u32 s41, s57, 0
    global_load_lds_dwordx4 v10, s[40:41]
    s_add_u32 s47, s47, 8192
    s_min_u32 s47, s47, 811008
    s_waitcnt vmcnt(9)
    ds_read_b64_tr_b16 v[92:93], v11 offset:2048
    ds_read_b64_tr_b16 v[94:95], v11 offset:2304
    ds_read_b128 v[60:63], v44
    ds_read_b128 v[64:67], v48
    ds_read_b128 v[68:71], v52
    ds_read_b128 v[72:75], v56
    s_waitcnt lgkmcnt(6)
    v_mfma_f32_32x32x16_bf16 a[0:15], v[96:99], v[76:79], a[0:15]
    v_mfma_f32_32x32x16_bf16 a[16:31], v[96:99], v[80:83], a[16:31]
    v_mfma_f32_32x32x16_bf16 a[32:47], v[96:99], v[84:87], a[32:47]
    v_mfma_f32_32x32x16_bf16 a[48:63], v[96:99], v[88:91], a[48:63]
    s_add_u32 m0, s30, 0
    s_add_u32 s40, s56, s47
    s_addc_u32 s41, s57, 0
    global_load_lds_dwordx4 v10, s[40:41]
    s_add_u32 s47, s47, 8192
    s_min_u32 s47, s47, 811008
    s_waitcnt vmcnt(9)
    ds_read_b64_tr_b16 v[96:97], v11 offset:3072
    ds_read_b64_tr_b16 v[98:99], v11 offset:3328
    ds_read_b128 v[76:79], v45
    ds_read_b128 v[80:83], v49
    ds_read_b128 v[84:87], v53
    ds_read_b128 v[88:91], v57
    s_waitcnt lgkmcnt(6)
    v_mfma_f32_32x32x16_bf16 a[0:15], v[92:95], v[60:63], a[0:15]
    v_mfma_f32_32x32x16_bf16 a[16:31], v[92:95], v[64:67], a[16:31]
    v_mfma_f32_32x32x16_bf16 a[32:47], v[92:95], v[68:71], a[32:47]
    v_mfma_f32_32x32x16_bf16 a[48:63], v[92:95], v[72:75], a[48:63]
    s_add_u32 m0, s30, 1024
    s_add_u32 s40, s56, s47
    s_addc_u32 s41, s57, 0
    global_load_lds_dwordx4 v10, s[40:41]
    s_add_u32 s47, s47, 8192
    s_min_u32 s47, s47, 811008
    s_waitcnt lgkmcnt(0)
    v_mfma_f32_32x32x16_bf16 a[0:15], v[96:99], v[76:79], a[0:15]
    v_mfma_f32_32x32x16_bf16 a[16:31], v[96:99], v[80:83], a[16:31]
    v_mfma_f32_32x32x16_bf16 a[32:47], v[96:99], v[84:87], a[32:47]
    v_mfma_f32_32x32x16_bf16 a[48:63], v[96:99], v[88:91], a[48:63]
    s_lshl_b32 s33, s26, 6
    v_lshrrev_b32 v2, 1, v12
    v_add_u32 v2, s33, v2
    global_load_dwordx2 v[164:165], v2, s[12:13] offset:0
    global_load_dwordx2 v[172:173], v2, s[14:15] offset:0
    global_load_dwordx2 v[166:167], v2, s[12:13] offset:16
    global_load_dwordx2 v[174:175], v2, s[14:15] offset:16
    global_load_dwordx2 v[168:169], v2, s[12:13] offset:32
    global_load_dwordx2 v[176:177], v2, s[14:15] offset:32
    global_load_dwordx2 v[170:171], v2, s[12:13] offset:48
    global_load_dwordx2 v[178:179], v2, s[14:15] offset:48
    s_nop 7
    s_nop 7
    s_barrier
    s_lshl_b32 s33, s24, 14
    v_lshl_add_u32 v2, v1, 4, s33
    ds_write_b128 v2, a[0:3] offset:0
    ds_write_b128 v2, a[4:7] offset:1024
    ds_write_b128 v2, a[8:11] offset:2048
    ds_write_b128 v2, a[12:15] offset:3072
    ds_write_b128 v2, a[16:19] offset:4096
    ds_write_b128 v2, a[20:23] offset:5120
    ds_write_b128 v2, a[24:27] offset:6144
    ds_write_b128 v2, a[28:31] offset:7168
    ds_write_b128 v2, a[32:35] offset:8192
    ds_write_b128 v2, a[36:39] offset:9216
    ds_write_b128 v2, a[40:43] offset:10240
    ds_write_b128 v2, a[44:47] offset:11264
    ds_write_b128 v2, a[48:51] offset:12288
    ds_write_b128 v2, a[52:55] offset:13312
    ds_write_b128 v2, a[56:59] offset:14336
    ds_write_b128 v2, a[60:63] offset:15360
    s_waitcnt lgkmcnt(0)
    s_barrier
    s_lshl_b32 s33, s24, 12
    v_lshl_add_u32 v2, v1, 4, s33
    ds_read_b128 v[100:103], v2 offset:0
    ds_read_b128 v[104:107], v2 offset:1024
    ds_read_b128 v[108:111], v2 offset:2048
    ds_read_b128 v[112:115], v2 offset:3072
    ds_read_b128 v[116:119], v2 offset:16384
    ds_read_b128 v[120:123], v2 offset:17408
    ds_read_b128 v[124:127], v2 offset:18432
    ds_read_b128 v[128:131], v2 offset:19456
    ds_read_b128 v[132:135], v2 offset:32768
    ds_read_b128 v[136:139], v2 offset:33792
    ds_read_b128 v[140:143], v2 offset:34816
    ds_read_b128 v[144:147], v2 offset:35840
    ds_read_b128 v[148:151], v2 offset:49152
    ds_read_b128 v[152:155], v2 offset:50176
    ds_read_b128 v[156:159], v2 offset:51200
    ds_read_b128 v[160:163], v2 offset:52224
    s_waitcnt lgkmcnt(0) vmcnt(0)
    s_mov_b32 s33, 0xffff0000
    s_mov_b32 s34, 0x3d372713
    s_mov_b32 s35, 0xc0135761
    v_mov_b32 v20, 0
    v_add_f32 v100, v100, v116
    v_add_f32 v132, v132, v148
    v_add_f32 v100, v100, v132
    v_cvt_pk_bf16_f32 v100, v100, v100
    v_lshlrev_b32 v100, 16, v100
    v_lshlrev_b32 v3, 16, v164
    v_lshlrev_b32 v4, 16, v172
    v_add_f32 v100, v100, v3
    v_cvt_pk_bf16_f32 v100, v100, v100
    v_lshlrev_b32 v100, 16, v100
    v_mul_f32 v3, v100, v100
    v_fma_f32 v3, v3, s34, 1.0
    v_mul_f32 v3, v3, v100
    v_mul_f32 v3, s35, v3
    v_exp_f32 v3, v3
    s_nop 0
    v_add_f32 v3, 1.0, v3
    v_rcp_f32 v3, v3
    s_nop 0
    v_mul_f32 v100, v100, v3
    v_cvt_pk_bf16_f32 v100, v100, v100
    v_lshlrev_b32 v100, 16, v100
    v_fmac_f32 v20, v100, v4
    v_add_f32 v101, v101, v117
    v_add_f32 v133, v133, v149
    v_add_f32 v101, v101, v133
    v_cvt_pk_bf16_f32 v101, v101, v101
    v_lshlrev_b32 v101, 16, v101
    v_and_b32 v3, s33, v164
    v_and_b32 v4, s33, v172
    v_add_f32 v101, v101, v3
    v_cvt_pk_bf16_f32 v101, v101, v101
    v_lshlrev_b32 v101, 16, v101
    v_mul_f32 v3, v101, v101
    v_fma_f32 v3, v3, s34, 1.0
    v_mul_f32 v3, v3, v101
    v_mul_f32 v3, s35, v3
    v_exp_f32 v3, v3
    s_nop 0
    v_add_f32 v3, 1.0, v3
    v_rcp_f32 v3, v3
    s_nop 0
    v_mul_f32 v101, v101, v3
    v_cvt_pk_bf16_f32 v101, v101, v101
    v_lshlrev_b32 v101, 16, v101
    v_fmac_f32 v20, v101, v4
    v_add_f32 v102, v102, v118
    v_add_f32 v134, v134, v150
    v_add_f32 v102, v102, v134
    v_cvt_pk_bf16_f32 v102, v102, v102
    v_lshlrev_b32 v102, 16, v102
    v_lshlrev_b32 v3, 16, v165
    v_lshlrev_b32 v4, 16, v173
    v_add_f32 v102, v102, v3
    v_cvt_pk_bf16_f32 v102, v102, v102
    v_lshlrev_b32 v102, 16, v102
    v_mul_f32 v3, v102, v102
    v_fma_f32 v3, v3, s34, 1.0
    v_mul_f32 v3, v3, v102
    v_mul_f32 v3, s35, v3
    v_exp_f32 v3, v3
    s_nop 0
    v_add_f32 v3, 1.0, v3
    v_rcp_f32 v3, v3
    s_nop 0
    v_mul_f32 v102, v102, v3
    v_cvt_pk_bf16_f32 v102, v102, v102
    v_lshlrev_b32 v102, 16, v102
    v_fmac_f32 v20, v102, v4
    v_add_f32 v103, v103, v119
    v_add_f32 v135, v135, v151
    v_add_f32 v103, v103, v135
    v_cvt_pk_bf16_f32 v103, v103, v103
    v_lshlrev_b32 v103, 16, v103
    v_and_b32 v3, s33, v165
    v_and_b32 v4, s33, v173
    v_add_f32 v103, v103, v3
    v_cvt_pk_bf16_f32 v103, v103, v103
    v_lshlrev_b32 v103, 16, v103
    v_mul_f32 v3, v103, v103
    v_fma_f32 v3, v3, s34, 1.0
    v_mul_f32 v3, v3, v103
    v_mul_f32 v3, s35, v3
    v_exp_f32 v3, v3
    s_nop 0
    v_add_f32 v3, 1.0, v3
    v_rcp_f32 v3, v3
    s_nop 0
    v_mul_f32 v103, v103, v3
    v_cvt_pk_bf16_f32 v103, v103, v103
    v_lshlrev_b32 v103, 16, v103
    v_fmac_f32 v20, v103, v4
    v_add_f32 v104, v104, v120
    v_add_f32 v136, v136, v152
    v_add_f32 v104, v104, v136
    v_cvt_pk_bf16_f32 v104, v104, v104
    v_lshlrev_b32 v104, 16, v104
    v_lshlrev_b32 v3, 16, v166
    v_lshlrev_b32 v4, 16, v174
    v_add_f32 v104, v104, v3
    v_cvt_pk_bf16_f32 v104, v104, v104
    v_lshlrev_b32 v104, 16, v104
    v_mul_f32 v3, v104, v104
    v_fma_f32 v3, v3, s34, 1.0
    v_mul_f32 v3, v3, v104
    v_mul_f32 v3, s35, v3
    v_exp_f32 v3, v3
    s_nop 0
    v_add_f32 v3, 1.0, v3
    v_rcp_f32 v3, v3
    s_nop 0
    v_mul_f32 v104, v104, v3
    v_cvt_pk_bf16_f32 v104, v104, v104
    v_lshlrev_b32 v104, 16, v104
    v_fmac_f32 v20, v104, v4
    v_add_f32 v105, v105, v121
    v_add_f32 v137, v137, v153
    v_add_f32 v105, v105, v137
    v_cvt_pk_bf16_f32 v105, v105, v105
    v_lshlrev_b32 v105, 16, v105
    v_and_b32 v3, s33, v166
    v_and_b32 v4, s33, v174
    v_add_f32 v105, v105, v3
    v_cvt_pk_bf16_f32 v105, v105, v105
    v_lshlrev_b32 v105, 16, v105
    v_mul_f32 v3, v105, v105
    v_fma_f32 v3, v3, s34, 1.0
    v_mul_f32 v3, v3, v105
    v_mul_f32 v3, s35, v3
    v_exp_f32 v3, v3
    s_nop 0
    v_add_f32 v3, 1.0, v3
    v_rcp_f32 v3, v3
    s_nop 0
    v_mul_f32 v105, v105, v3
    v_cvt_pk_bf16_f32 v105, v105, v105
    v_lshlrev_b32 v105, 16, v105
    v_fmac_f32 v20, v105, v4
    v_add_f32 v106, v106, v122
    v_add_f32 v138, v138, v154
    v_add_f32 v106, v106, v138
    v_cvt_pk_bf16_f32 v106, v106, v106
    v_lshlrev_b32 v106, 16, v106
    v_lshlrev_b32 v3, 16, v167
    v_lshlrev_b32 v4, 16, v175
    v_add_f32 v106, v106, v3
    v_cvt_pk_bf16_f32 v106, v106, v106
    v_lshlrev_b32 v106, 16, v106
    v_mul_f32 v3, v106, v106
    v_fma_f32 v3, v3, s34, 1.0
    v_mul_f32 v3, v3, v106
    v_mul_f32 v3, s35, v3
    v_exp_f32 v3, v3
    s_nop 0
    v_add_f32 v3, 1.0, v3
    v_rcp_f32 v3, v3
    s_nop 0
    v_mul_f32 v106, v106, v3
    v_cvt_pk_bf16_f32 v106, v106, v106
    v_lshlrev_b32 v106, 16, v106
    v_fmac_f32 v20, v106, v4
    v_add_f32 v107, v107, v123
    v_add_f32 v139, v139, v155
    v_add_f32 v107, v107, v139
    v_cvt_pk_bf16_f32 v107, v107, v107
    v_lshlrev_b32 v107, 16, v107
    v_and_b32 v3, s33, v167
    v_and_b32 v4, s33, v175
    v_add_f32 v107, v107, v3
    v_cvt_pk_bf16_f32 v107, v107, v107
    v_lshlrev_b32 v107, 16, v107
    v_mul_f32 v3, v107, v107
    v_fma_f32 v3, v3, s34, 1.0
    v_mul_f32 v3, v3, v107
    v_mul_f32 v3, s35, v3
    v_exp_f32 v3, v3
    s_nop 0
    v_add_f32 v3, 1.0, v3
    v_rcp_f32 v3, v3
    s_nop 0
    v_mul_f32 v107, v107, v3
    v_cvt_pk_bf16_f32 v107, v107, v107
    v_lshlrev_b32 v107, 16, v107
    v_fmac_f32 v20, v107, v4
    v_add_f32 v108, v108, v124
    v_add_f32 v140, v140, v156
    v_add_f32 v108, v108, v140
    v_cvt_pk_bf16_f32 v108, v108, v108
    v_lshlrev_b32 v108, 16, v108
    v_lshlrev_b32 v3, 16, v168
    v_lshlrev_b32 v4, 16, v176
    v_add_f32 v108, v108, v3
    v_cvt_pk_bf16_f32 v108, v108, v108
    v_lshlrev_b32 v108, 16, v108
    v_mul_f32 v3, v108, v108
    v_fma_f32 v3, v3, s34, 1.0
    v_mul_f32 v3, v3, v108
    v_mul_f32 v3, s35, v3
    v_exp_f32 v3, v3
    s_nop 0
    v_add_f32 v3, 1.0, v3
    v_rcp_f32 v3, v3
    s_nop 0
    v_mul_f32 v108, v108, v3
    v_cvt_pk_bf16_f32 v108, v108, v108
    v_lshlrev_b32 v108, 16, v108
    v_fmac_f32 v20, v108, v4
    v_add_f32 v109, v109, v125
    v_add_f32 v141, v141, v157
    v_add_f32 v109, v109, v141
    v_cvt_pk_bf16_f32 v109, v109, v109
    v_lshlrev_b32 v109, 16, v109
    v_and_b32 v3, s33, v168
    v_and_b32 v4, s33, v176
    v_add_f32 v109, v109, v3
    v_cvt_pk_bf16_f32 v109, v109, v109
    v_lshlrev_b32 v109, 16, v109
    v_mul_f32 v3, v109, v109
    v_fma_f32 v3, v3, s34, 1.0
    v_mul_f32 v3, v3, v109
    v_mul_f32 v3, s35, v3
    v_exp_f32 v3, v3
    s_nop 0
    v_add_f32 v3, 1.0, v3
    v_rcp_f32 v3, v3
    s_nop 0
    v_mul_f32 v109, v109, v3
    v_cvt_pk_bf16_f32 v109, v109, v109
    v_lshlrev_b32 v109, 16, v109
    v_fmac_f32 v20, v109, v4
    v_add_f32 v110, v110, v126
    v_add_f32 v142, v142, v158
    v_add_f32 v110, v110, v142
    v_cvt_pk_bf16_f32 v110, v110, v110
    v_lshlrev_b32 v110, 16, v110
    v_lshlrev_b32 v3, 16, v169
    v_lshlrev_b32 v4, 16, v177
    v_add_f32 v110, v110, v3
    v_cvt_pk_bf16_f32 v110, v110, v110
    v_lshlrev_b32 v110, 16, v110
    v_mul_f32 v3, v110, v110
    v_fma_f32 v3, v3, s34, 1.0
    v_mul_f32 v3, v3, v110
    v_mul_f32 v3, s35, v3
    v_exp_f32 v3, v3
    s_nop 0
    v_add_f32 v3, 1.0, v3
    v_rcp_f32 v3, v3
    s_nop 0
    v_mul_f32 v110, v110, v3
    v_cvt_pk_bf16_f32 v110, v110, v110
    v_lshlrev_b32 v110, 16, v110
    v_fmac_f32 v20, v110, v4
    v_add_f32 v111, v111, v127
    v_add_f32 v143, v143, v159
    v_add_f32 v111, v111, v143
    v_cvt_pk_bf16_f32 v111, v111, v111
    v_lshlrev_b32 v111, 16, v111
    v_and_b32 v3, s33, v169
    v_and_b32 v4, s33, v177
    v_add_f32 v111, v111, v3
    v_cvt_pk_bf16_f32 v111, v111, v111
    v_lshlrev_b32 v111, 16, v111
    v_mul_f32 v3, v111, v111
    v_fma_f32 v3, v3, s34, 1.0
    v_mul_f32 v3, v3, v111
    v_mul_f32 v3, s35, v3
    v_exp_f32 v3, v3
    s_nop 0
    v_add_f32 v3, 1.0, v3
    v_rcp_f32 v3, v3
    s_nop 0
    v_mul_f32 v111, v111, v3
    v_cvt_pk_bf16_f32 v111, v111, v111
    v_lshlrev_b32 v111, 16, v111
    v_fmac_f32 v20, v111, v4
    v_add_f32 v112, v112, v128
    v_add_f32 v144, v144, v160
    v_add_f32 v112, v112, v144
    v_cvt_pk_bf16_f32 v112, v112, v112
    v_lshlrev_b32 v112, 16, v112
    v_lshlrev_b32 v3, 16, v170
    v_lshlrev_b32 v4, 16, v178
    v_add_f32 v112, v112, v3
    v_cvt_pk_bf16_f32 v112, v112, v112
    v_lshlrev_b32 v112, 16, v112
    v_mul_f32 v3, v112, v112
    v_fma_f32 v3, v3, s34, 1.0
    v_mul_f32 v3, v3, v112
    v_mul_f32 v3, s35, v3
    v_exp_f32 v3, v3
    s_nop 0
    v_add_f32 v3, 1.0, v3
    v_rcp_f32 v3, v3
    s_nop 0
    v_mul_f32 v112, v112, v3
    v_cvt_pk_bf16_f32 v112, v112, v112
    v_lshlrev_b32 v112, 16, v112
    v_fmac_f32 v20, v112, v4
    v_add_f32 v113, v113, v129
    v_add_f32 v145, v145, v161
    v_add_f32 v113, v113, v145
    v_cvt_pk_bf16_f32 v113, v113, v113
    v_lshlrev_b32 v113, 16, v113
    v_and_b32 v3, s33, v170
    v_and_b32 v4, s33, v178
    v_add_f32 v113, v113, v3
    v_cvt_pk_bf16_f32 v113, v113, v113
    v_lshlrev_b32 v113, 16, v113
    v_mul_f32 v3, v113, v113
    v_fma_f32 v3, v3, s34, 1.0
    v_mul_f32 v3, v3, v113
    v_mul_f32 v3, s35, v3
    v_exp_f32 v3, v3
    s_nop 0
    v_add_f32 v3, 1.0, v3
    v_rcp_f32 v3, v3
    s_nop 0
    v_mul_f32 v113, v113, v3
    v_cvt_pk_bf16_f32 v113, v113, v113
    v_lshlrev_b32 v113, 16, v113
    v_fmac_f32 v20, v113, v4
    v_add_f32 v114, v114, v130
    v_add_f32 v146, v146, v162
    v_add_f32 v114, v114, v146
    v_cvt_pk_bf16_f32 v114, v114, v114
    v_lshlrev_b32 v114, 16, v114
    v_lshlrev_b32 v3, 16, v171
    v_lshlrev_b32 v4, 16, v179
    v_add_f32 v114, v114, v3
    v_cvt_pk_bf16_f32 v114, v114, v114
    v_lshlrev_b32 v114, 16, v114
    v_mul_f32 v3, v114, v114
    v_fma_f32 v3, v3, s34, 1.0
    v_mul_f32 v3, v3, v114
    v_mul_f32 v3, s35, v3
    v_exp_f32 v3, v3
    s_nop 0
    v_add_f32 v3, 1.0, v3
    v_rcp_f32 v3, v3
    s_nop 0
    v_mul_f32 v114, v114, v3
    v_cvt_pk_bf16_f32 v114, v114, v114
    v_lshlrev_b32 v114, 16, v114
    v_fmac_f32 v20, v114, v4
    v_add_f32 v115, v115, v131
    v_add_f32 v147, v147, v163
    v_add_f32 v115, v115, v147
    v_cvt_pk_bf16_f32 v115, v115, v115
    v_lshlrev_b32 v115, 16, v115
    v_and_b32 v3, s33, v171
    v_and_b32 v4, s33, v179
    v_add_f32 v115, v115, v3
    v_cvt_pk_bf16_f32 v115, v115, v115
    v_lshlrev_b32 v115, 16, v115
    v_mul_f32 v3, v115, v115
    v_fma_f32 v3, v3, s34, 1.0
    v_mul_f32 v3, v3, v115
    v_mul_f32 v3, s35, v3
    v_exp_f32 v3, v3
    s_nop 0
    v_add_f32 v3, 1.0, v3
    v_rcp_f32 v3, v3
    s_nop 0
    v_mul_f32 v115, v115, v3
    v_cvt_pk_bf16_f32 v115, v115, v115
    v_lshlrev_b32 v115, 16, v115
    v_fmac_f32 v20, v115, v4
    v_mov_b32 v21, v20
    s_nop 1
    v_permlane32_swap_b32 v20, v21
    s_nop 1
    v_add_f32 v20, v20, v21
    s_lshl_b32 s33, s2, 9
    s_lshl_b32 s34, s24, 7
    s_add_u32 s33, s33, s34
    v_lshl_add_u32 v2, v1, 2, s33
    s_mov_b64 exec, 0xffffffff
    global_store_dword v2, v20, s[22:23] sc1
    s_mov_b64 exec, -1
    s_waitcnt vmcnt(0)
    s_barrier
    s_cmp_lg_u32 s24, 0
    s_cbranch_scc1 L_end
    s_lshl_b32 s33, s25, 2
    v_mov_b32 v2, s33
    v_mov_b32 v3, 1
    s_mov_b64 exec, 1
    global_atomic_add v4, v2, v3, s[20:21] sc0 sc1
    s_waitcnt vmcnt(0)
    v_readfirstlane_b32 s33, v4
    s_mov_b64 exec, -1
    s_cmp_lg_u32 s33, 7
    s_cbranch_scc1 L_end
    s_lshl_b32 s33, s25, 12
    v_lshl_add_u32 v2, v1, 3, s33
    global_load_dwordx2 v[100:101], v2, s[22:23] offset:0 sc1
    global_load_dwordx2 v[102:103], v2, s[22:23] offset:512 sc1
    global_load_dwordx2 v[104:105], v2, s[22:23] offset:1024 sc1
    global_load_dwordx2 v[106:107], v2, s[22:23] offset:1536 sc1
    global_load_dwordx2 v[108:109], v2, s[22:23] offset:2048 sc1
    global_load_dwordx2 v[110:111], v2, s[22:23] offset:2560 sc1
    global_load_dwordx2 v[112:113], v2, s[22:23] offset:3072 sc1
    global_load_dwordx2 v[114:115], v2, s[22:23] offset:3584 sc1
    s_lshl_b32 s33, s25, 9
    s_add_u32 s33, s33, 131072
    v_lshl_add_u32 v3, v1, 3, s33
    global_load_dwordx2 v[116:117], v3, s[22:23] sc1
    v_mov_b32 v4, 0
    global_load_ushort v118, v4, s[16:17]
    s_waitcnt vmcnt(0)
    v_lshlrev_b32 v118, 16, v118
    v_add_f32 v100, v100, v102
    v_add_f32 v100, v100, v104
    v_add_f32 v100, v100, v106
    v_add_f32 v100, v100, v108
    v_add_f32 v100, v100, v110
    v_add_f32 v100, v100, v112
    v_add_f32 v100, v100, v114
    v_cvt_pk_bf16_f32 v100, v100, v100
    v_lshlrev_b32 v100, 16, v100
    v_cvt_pk_bf16_f32 v116, v116, v116
    v_lshlrev_b32 v116, 16, v116
    v_add_f32 v100, v100, v118
    v_cvt_pk_bf16_f32 v100, v100, v100
    v_lshlrev_b32 v100, 16, v100
    v_add_f32 v100, v100, v116
    v_add_f32 v101, v101, v103
    v_add_f32 v101, v101, v105
    v_add_f32 v101, v101, v107
    v_add_f32 v101, v101, v109
    v_add_f32 v101, v101, v111
    v_add_f32 v101, v101, v113
    v_add_f32 v101, v101, v115
    v_cvt_pk_bf16_f32 v101, v101, v101
    v_lshlrev_b32 v101, 16, v101
    v_cvt_pk_bf16_f32 v117, v117, v117
    v_lshlrev_b32 v117, 16, v117
    v_add_f32 v101, v101, v118
    v_cvt_pk_bf16_f32 v101, v101, v101
    v_lshlrev_b32 v101, 16, v101
    v_add_f32 v101, v101, v117
    v_cvt_pk_bf16_f32 v100, v100, v101
    s_lshl_b32 s33, s25, 8
    v_lshl_add_u32 v2, v1, 2, s33
    global_store_dword v2, v100, s[18:19]
    s_waitcnt vmcnt(0)
L_end:
s_endpgm
.section .rodata,"a"
.p2align 6
.amdhsa_kernel standalone__deep_cross_pnn__recsys_kernel
  .amdhsa_next_free_vgpr 256
  .amdhsa_next_free_sgpr 102
  .amdhsa_accum_offset 192
  .amdhsa_group_segment_fixed_size 0
  .amdhsa_kernarg_size 80
  .amdhsa_user_sgpr_count 2
  .amdhsa_user_sgpr_kernarg_segment_ptr 1
  .amdhsa_system_sgpr_workgroup_id_x 1
.end_amdhsa_kernel
```
